```python
import torch

def _softmax(x, axis=-1):
    return torch.softmax(x, dim=axis)
def _gelu(x):
    return torch.nn.functional.gelu(x, approximate="tanh")
def _silu(x):
    return torch.nn.functional.silu(x)
def _sigmoid(x):
    return torch.sigmoid(x)
def _layernorm(x, axis=-1, eps=1e-5):
    m = x.mean(dim=axis, keepdim=True)
    v = x.var(dim=axis, keepdim=True, unbiased=False)
    return (x - m) / torch.sqrt(v + eps)
def _scatter_add(tgt, idx, src, axis=0):
    return tgt.clone().index_add_(axis, idx, src)
def _segment_sum(src, seg, n):
    out = torch.zeros((n,) + src.shape[1:], dtype=src.dtype)
    return out.index_add_(0, seg, src)
def _pad(x, pw):
    flat = tuple(v for pair in reversed(pw) for v in pair)
    return torch.nn.functional.pad(x, flat)

kernel_name = 'recurrent_scan__ssm_conv_h3__glu_gated_bilinear__prompt'

def setup_inputs():

    _w = (lambda a: (lambda t: t.to(torch.bfloat16) if t.is_floating_point() else t)(torch.as_tensor(a)))
    def _A_setup():
        B, S, D = 1, 2048, 512
        ks = 4
        return {
            "q": _w((lambda *s: torch.randn(*s, dtype=torch.bfloat16) * 0.05)(B, S, D)),
            "k": _w((lambda *s: torch.randn(*s, dtype=torch.bfloat16) * 0.8)(B, S, D)),
            "v": _w((lambda *s: torch.randn(*s, dtype=torch.bfloat16) * 0.8)(B, S, D)),
            "shift_k": _w((lambda *s: torch.randn(*s, dtype=torch.bfloat16) * 0.8)(D, ks) * 0.5),
            "ssm_k": _w((lambda *s: torch.randn(*s, dtype=torch.bfloat16) * 0.8)(D, S) * (1.0 / S ** 0.5)),
            "ssm_D": _w((lambda *s: torch.randn(*s, dtype=torch.bfloat16) * 0.8)(D)),
        }
    _A_in = _A_setup()

    def _B_setup():
        B, S, D, F = 1, 2048, 512, 1376
        return {
            "x": _w((lambda *s: torch.randn(*s, dtype=torch.bfloat16) * 0.05)(B, S, D)),
            "w_gate": _w((lambda *s: torch.randn(*s, dtype=torch.bfloat16) * 0.2)(D, F) * (D ** -0.5)),
            "w_up": _w((lambda *s: torch.randn(*s, dtype=torch.bfloat16) * 0.2)(D, F) * (D ** -0.5)),
            "w_down": _w((lambda *s: torch.randn(*s, dtype=torch.bfloat16) * 0.2)(F, D) * (F ** -0.5)),
        }
    _B_in = _B_setup()

    return {
        "A_q": _A_in["q"],
        "A_k": _A_in["k"],
        "A_v": _A_in["v"],
        "A_shift_k": _A_in["shift_k"],
        "A_ssm_k": _A_in["ssm_k"],
        "A_ssm_D": _A_in["ssm_D"],
        "B_x": _B_in["x"],
        "B_w_gate": _B_in["w_gate"],
        "B_w_up": _B_in["w_up"],
        "B_w_down": _B_in["w_down"],
    }

def reference(A_q, A_k, A_v, A_shift_k, A_ssm_k, A_ssm_D, B_x, B_w_gate, B_w_up, B_w_down):
    def _A_ref(q, k, v, shift_k, ssm_k, ssm_D):
        B, S, D = q.shape
        ks = shift_k.shape[-1]
        k_pad = _pad(k, ((0, 0), (ks - 1, 0), (0, 0)))
        k_shift = torch.zeros_like(k)
        for t in range(ks):
            k_shift = k_shift + k_pad[:, t:t + S, :] * shift_k[:, ks - 1 - t][None, None, :]
        kv = k_shift * v
        L = 2 * S
        kv_pad = _pad(kv, ((0, 0), (0, S), (0, 0)))
        kf_pad = _pad(ssm_k, ((0, 0), (0, S)))
        kv_f = (lambda x, axes=(-2,-1): torch.fft.rfft2(x.float(), dim=axes))(kv_pad[:, None, :, :], axes=(1, 2))
        kf_f = (lambda x, axes=(-2,-1): torch.fft.rfft2(x.float(), dim=axes))(kf_pad[:, None, :], axes=(1, 2))
        kf_f = (lambda x, *d: x.permute(*d))(kf_f, 1, 2, 0)
        y_f = kv_f * kf_f[None, :, :, :]
        y = (lambda x, s, axes=(-2,-1): torch.fft.irfft2(x, s=s, dim=axes).to(torch.bfloat16))(y_f, (1, L), axes=(1, 2))[:, 0, :S, :]
        y = y + kv * ssm_D[None, None, :]
        return q * y

    def _B_ref(x, w_gate, w_up, w_down):
        g = torch.einsum("bsd,df->bsf", x, w_gate)
        u = torch.einsum("bsd,df->bsf", x, w_up)
        h = g * u
        return torch.einsum("bsf,fd->bsd", h, w_down)

    x = A_q
    xn = _layernorm(x, axis=-1)
    s = _A_ref(xn, A_k, A_v, A_shift_k, A_ssm_k, A_ssm_D)
    g = _silu(_B_ref(xn, B_w_gate, B_w_up, B_w_down))
    return x + s * g
```

```asm
; @launch grid=(256,1,1) block=(512,1,1) lds=163840
.amdgcn_target "amdgcn-amd-amdhsa--gfx950"
.text
.p2align 12
.globl recurrent_scan__ssm_conv_h3__glu_gated_bilinear__prompt_kernel
.p2align 8
.type recurrent_scan__ssm_conv_h3__glu_gated_bilinear__prompt_kernel,@function
recurrent_scan__ssm_conv_h3__glu_gated_bilinear__prompt_kernel:
L_start:
    s_load_dwordx2 s[8:9], s[0:1], 8
    s_load_dwordx2 s[28:29], s[0:1], 64
    s_load_dwordx2 s[12:13], s[0:1], 16
    s_load_dwordx2 s[16:17], s[0:1], 24
    s_load_dwordx2 s[4:5], s[0:1], 0
    s_load_dwordx2 s[24:25], s[0:1], 56
    s_cmp_ge_u32 s2, 256
    s_cbranch_scc1 L_end
    v_lshrrev_b32 v1, 6, v0
    s_and_b32 s50, s2, 7
    s_lshr_b32 s51, s2, 3
    v_readfirstlane_b32 s3, v1
    s_and_b32 s58, s2, 1
    s_and_b32 s59, s51, 3
    s_lshr_b32 s60, s2, 5
    s_lshr_b32 s61, s50, 1
    s_lshl2_add_u32 s52, s61, s59
    s_lshl2_add_u32 s55, s50, s59
    s_xor_b32 s56, s60, 4
    s_mul_i32 s62, s50, 7
    s_and_b32 s54, s62, 7
    s_lshr_b32 s59, s59, 1
    s_xor_b32 s59, s59, s58
    s_add_u32 s59, s59, 14
    s_mul_i32 s58, s58, 7
    s_add_u32 s58, s58, s60
    s_cmp_eq_u32 s60, 7
    s_cselect_b32 s53, s59, s58
    s_mov_b32 s6, 2097152
    s_mov_b32 s7, 0x20000
    s_cmp_lt_u32 s3, 4
    s_cbranch_scc0 L_Y
    s_getpc_b64 s[60:61]
L_pc:
    s_mul_i32 s58, s51, 760
    s_add_u32 s60, s60, s58
    s_addc_u32 s61, s61, 0
    v_min_u32 v2, 95, v0
    v_lshlrev_b32 v2, 3, v2
    v_mov_b32 v3, 0
    v_lshl_add_u64 v[2:3], v[2:3], 0, s[60:61]
    global_load_dword v11, v[2:3], off
    v_and_b32 v0, 63, v0
    s_mov_b64 s[10:11], s[6:7]
    s_mov_b64 s[14:15], s[6:7]
    s_movk_i32 s18, 4096
    s_mov_b32 s19, s7
    s_lshl2_add_u32 s60, s55, s3
    s_lshl_b32 s61, s60, 14
    s_lshl_b32 s62, s56, 7
    s_add_u32 s61, s61, s62
    v_and_b32 v1, 31, v0
    v_lshrrev_b32 v2, 5, v0
    v_lshlrev_b32 v3, 13, v2
    v_lshl_add_u32 v3, v1, 2, v3
    v_add_u32 v4, s61, v3
    v_subrev_u32 v5, 3072, v4
    s_lshl_b32 s62, s56, 9
    v_lshl_add_u32 v6, v1, 4, s62
    s_lshl4_add_u32 s63, s52, s53
    s_lshl2_add_u32 s63, s63, s3
    s_lshl_b32 s64, s63, 11
    v_lshlrev_b32 v7, 10, v2
    v_lshl_add_u32 v7, v1, 4, v7
    v_add_u32 v7, s64, v7
    s_waitcnt lgkmcnt(0)
    s_xor_b32 s66, s53, 15
    s_or_b32 s66, s66, s3
    s_cbranch_scc1 L_noclear
    s_load_dwordx2 s[44:45], s[0:1], 96
    s_mov_b32 s46, 11534336
    s_mov_b32 s47, 0x20000
    v_mov_b32 v10, 0
    v_lshlrev_b32 v8, 7, v0
    s_mul_i32 s61, s52, 1536
    s_mov_b64 exec, 0xfff
    s_waitcnt lgkmcnt(0)
    buffer_store_dword v10, v8, s[44:47], s61 offen sc1
    s_mov_b64 exec, -1
L_noclear:
    buffer_load_dword v16, v5, s[8:11], 0 offen offset:0 nt
    buffer_load_dword v17, v5, s[8:11], 0 offen offset:1024 nt
    buffer_load_dword v18, v5, s[8:11], 0 offen offset:2048 nt
    buffer_load_dword v19, v4, s[8:11], 0 offen offset:0 nt
    buffer_load_dword v20, v4, s[8:11], 0 offen offset:1024 nt
    buffer_load_dword v21, v4, s[8:11], 0 offen offset:2048 nt
    buffer_load_dword v22, v4, s[8:11], 0 offen offset:3072 nt
    buffer_load_dword v23, v4, s[8:11], s18 offen offset:0 nt
    buffer_load_dword v24, v4, s[8:11], s18 offen offset:1024 nt
    buffer_load_dword v25, v4, s[8:11], s18 offen offset:2048 nt
    buffer_load_dword v26, v4, s[8:11], s18 offen offset:3072 nt
    buffer_load_dwordx4 v[36:39], v6, s[16:19], 0 offen
    buffer_load_dword v28, v4, s[12:15], 0 offen offset:0 nt
    buffer_load_dword v29, v4, s[12:15], 0 offen offset:1024 nt
    buffer_load_dword v30, v4, s[12:15], 0 offen offset:2048 nt
    buffer_load_dword v31, v4, s[12:15], 0 offen offset:3072 nt
    buffer_load_dword v32, v4, s[12:15], s18 offen offset:0 nt
    buffer_load_dword v33, v4, s[12:15], s18 offen offset:1024 nt
    buffer_load_dword v34, v4, s[12:15], s18 offen offset:2048 nt
    buffer_load_dword v35, v4, s[12:15], s18 offen offset:3072 nt
    buffer_load_dwordx4 v[40:43], v7, s[4:7], 0 offen
    buffer_load_dwordx4 v[44:47], v7, s[4:7], 0 offen offset:512
    s_branch L_X2
L_Y:
    v_and_b32 v0, 63, v0
    s_sub_u32 s62, s3, 4
    s_mov_b32 s26, 1409024
    s_mov_b32 s27, 0x20000
    s_mov_b32 s30, 1409024
    s_mov_b32 s31, 0x20000
    s_mul_i32 s63, s62, 44032
    s_mul_i32 s64, s53, 192
    s_add_u32 s63, s63, s64
    s_movk_i32 s65, 2752
    s_sub_u32 s64, s65, s64
    s_lshr_b32 s64, s64, 4
    s_cmp_eq_u32 s53, 15
    s_cselect_b32 s64, 0, s64
    v_mov_b32 v11, 0x80000000
    v_add_u32 v1, 0, v0
    v_mul_u32_u24 v2, 43691, v1
    v_lshrrev_b32 v2, 19, v2
    v_mul_u32_u24 v3, 12, v2
    v_sub_u32 v1, v1, v3
    v_lshrrev_b32 v3, 2, v2
    v_and_b32 v3, 2, v3
    v_xor_b32 v1, v1, v3
    v_cmp_gt_u32 vcc, s64, v1
    v_mul_u32_u24 v2, s65, v2
    v_lshl_add_u32 v2, v1, 4, v2
    v_add_u32 v2, s63, v2
    v_cndmask_b32 v8, v11, v2, vcc
    v_add_u32 v1, 64, v0
    v_mul_u32_u24 v2, 43691, v1
    v_lshrrev_b32 v2, 19, v2
    v_mul_u32_u24 v3, 12, v2
    v_sub_u32 v1, v1, v3
    v_lshrrev_b32 v3, 2, v2
    v_and_b32 v3, 2, v3
    v_xor_b32 v1, v1, v3
    v_cmp_gt_u32 vcc, s64, v1
    v_mul_u32_u24 v2, s65, v2
    v_lshl_add_u32 v2, v1, 4, v2
    v_add_u32 v2, s63, v2
    v_cndmask_b32 v9, v11, v2, vcc
    v_add_u32 v1, 128, v0
    v_mul_u32_u24 v2, 43691, v1
    v_lshrrev_b32 v2, 19, v2
    v_mul_u32_u24 v3, 12, v2
    v_sub_u32 v1, v1, v3
    v_lshrrev_b32 v3, 2, v2
    v_and_b32 v3, 2, v3
    v_xor_b32 v1, v1, v3
    v_cmp_gt_u32 vcc, s64, v1
    v_mul_u32_u24 v2, s65, v2
    v_lshl_add_u32 v2, v1, 4, v2
    v_add_u32 v2, s63, v2
    v_cndmask_b32 v10, v11, v2, vcc
    v_lshrrev_b32 v17, 3, v0
    v_and_b32 v18, 7, v0
    v_lshrrev_b32 v2, 4, v0
    v_xor_b32 v3, v18, v2
    v_lshlrev_b32 v3, 4, v3
    v_lshl_add_u32 v16, v17, 10, v3
    s_lshl2_add_u32 s63, s52, s62
    s_lshl_b32 s63, s63, 15
    v_add_u32 v4, s63, v16
    v_xor_b32 v5, 64, v4
    v_add_u32 v5, 8192, v5
    v_add_u32 v6, 16384, v4
    v_add_u32 v7, 16384, v5
    s_lshl_b32 s63, s62, 12
    s_mul_i32 s64, s62, 3072
    s_add_u32 s64, s64, 16384
    s_mov_b32 s65, s54
    s_lshr_b32 s60, s51, 2
    s_add_u32 s60, s60, s51
    s_and_b32 s60, s60, 3
    s_mov_b32 s65, 1733571088
    s_cmp_eq_u32 s60, 1
    s_cselect_b32 s65, 1969496848, s65
    s_cmp_eq_u32 s60, 2
    s_cselect_b32 s65, 1985167873, s65
    s_cmp_eq_u32 s60, 3
    s_cselect_b32 s65, 1984242433, s65
    s_waitcnt lgkmcnt(0)
    s_bfe_u32 s67, s65, 196608
    s_add_u32 s67, s67, s54
    s_and_b32 s67, s67, 7
    s_lshl_b32 s66, s67, 7
    s_mul_i32 s67, s67, 176128
    s_cmp_eq_u32 s53, 15
    s_cselect_b32 s66, 0x40000000, s66
    s_add_u32 m0, s63, 0
    s_nop 0
    buffer_load_dwordx4 v4, s[4:7], s66 offen  lds
    s_add_u32 m0, s63, 1024
    s_nop 0
    buffer_load_dwordx4 v5, s[4:7], s66 offen  lds
    s_add_u32 m0, s63, 2048
    s_nop 0
    buffer_load_dwordx4 v6, s[4:7], s66 offen  lds
    s_load_dwordx2 s[44:45], s[0:1], 96
    s_and_b32 s59, s51, 3
    s_mul_i32 s59, s59, 8
    s_and_b32 s59, s59, 63
    s_lshr_b32 s57, s51, 2
    s_mul_i32 s57, s57, 8
    s_add_u32 s57, s57, s59
    s_and_b32 s57, s57, 15
    s_mul_i32 s59, s50, 4
    s_add_u32 s57, s57, s59
    s_and_b32 s57, s57, 31
    s_mul_i32 s57, s57, 11
    s_lshr_b32 s57, s57, 4
    s_mov_b32 s59, 1
    s_mov_b32 s46, 11534336
    s_mov_b32 s47, 0x20000
    s_load_dwordx2 s[20:21], s[0:1], 32
    s_load_dwordx2 s[48:49], s[0:1], 40
    s_load_dwordx2 s[32:33], s[0:1], 72
    s_load_dwordx2 s[40:41], s[0:1], 88
    s_mov_b32 s22, 2097152
    s_mov_b32 s23, 0x20000
    s_mov_b32 s34, 1409024
    s_mov_b32 s35, 0x20000
    s_add_u32 m0, s63, 3072
    s_nop 0
    buffer_load_dwordx4 v7, s[4:7], s66 offen  lds
    v_and_b32 v1, 15, v0
    s_lshl2_add_u32 s60, s62, 150016
    v_mov_b32 v14, s60
    s_xor_b32 s60, s60, 4
    v_mov_b32 v12, s60
    v_and_b32 v15, 3, v0
    v_lshlrev_b32 v15, 2, v15
    v_add_u32 v15, 150016, v15
    v_mov_b32 v13, 1
    s_lshr_b32 s68, s62, 1
    s_and_b32 s69, s62, 1
    s_and_b32 s60, s51, 15
    s_lshl1_add_u32 s60, s60, s68
    s_lshr_b32 s61, s51, 4
    s_lshl1_add_u32 s60, s60, s61
    s_lshl_b32 s61, s50, 6
    s_add_u32 s70, s60, s61
    s_waitcnt lgkmcnt(0)
    s_lshl_b32 s60, s70, 12
    s_load_dword s36, s[20:21], s60
    s_andn2_b32 s61, s70, 1
    s_lshl_b32 s61, s61, 1
    s_load_dword s72, s[48:49], s61
    v_lshrrev_b32 v3, 2, v1
    v_lshl_add_u32 v3, v2, 3, v3
    v_mul_u32_u24 v3, 192, v3
    v_and_b32 v184, 3, v1
    v_lshl_add_u32 v3, v184, 3, v3
    s_add_u32 m0, s64, 0
    s_nop 0
    buffer_load_dwordx4 v8, s[24:27], s67 offen  lds
    s_mul_i32 s60, s68, 12288
    s_add_u32 s60, s60, 16384
    v_add_u32 v3, s60, v3
    v_and_b32 v184, 1, v2
    s_mul_i32 s60, s69, 3
    s_add_u32 s61, s60, 1
    v_xor_b32 v185, s61, v184
    v_xor_b32 v184, s60, v184
    v_lshl_add_u32 v184, v184, 5, v3
    v_lshl_add_u32 v185, v185, 5, v3
    v_mov_b32 v72, 0x3f803f80
    v_mov_b32 v73, 0x3f803f80
    v_mov_b32 v74, 0x3f803f80
    v_mov_b32 v75, 0x3f803f80
    s_lshl_b32 s38, s53, 7
    s_add_u32 s38, s38, 19456
    s_mul_i32 s60, s53, 3072
    s_mul_i32 s61, s62, 192
    s_add_u32 s60, s60, s61
    s_add_u32 s60, s60, 32768
    v_lshl_add_u32 v3, v0, 2, s60
    v_cmp_gt_u32 vcc, 48, v0
    s_lshr_b32 s61, s52, 2
    s_and_b32 s39, s51, 3
    s_add_u32 m0, s64, 12288
    s_nop 0
    buffer_load_dwordx4 v8, s[28:31], s67 offen  lds
    s_mul_i32 s61, s61, 768
    s_add_u32 s60, s60, s61
    s_xor_b32 s43, s39, s62
    s_cmp_eq_u32 s43, 0
    s_cselect_b32 s60, s60, 0x40000000
    v_lshl_add_u32 v186, v2, 4, s60
    v_cndmask_b32 v187, v11, v3, vcc
    v_add_u32 v188, 3072, v187
    s_lshl4_add_u32 s60, s52, s53
    s_lshl_b32 s60, s60, 6
    s_add_u32 s60, s60, 229376
    s_cmp_eq_u32 s39, s62
    s_cselect_b32 s60, s60, 0x40000000
    v_lshl_add_u32 v189, v2, 4, s60
    v_lshlrev_b32 v3, 4, v2
    v_add_u32 v190, 163328, v3
    v_xor_b32 v191, v18, v17
    v_lshlrev_b32 v191, 4, v191
    v_lshl_add_u32 v191, v17, 7, v191
    s_lshl_b32 s60, s62, 11
    s_add_u32 s60, s60, 150528
    v_add_u32 v191, s60, v191
    v_lshlrev_b32 v192, 4, v18
    v_lshl_add_u32 v192, v17, 12, v192
    s_add_u32 m0, s64, 1024
    s_nop 0
    buffer_load_dwordx4 v9, s[24:27], s67 offen  lds
    s_lshl2_add_u32 s60, s56, s62
    s_lshl_b32 s60, s60, 16
    s_lshl_b32 s61, s55, 7
    s_sub_u32 s60, s60, s61
    s_add_u32 s60, s60, 1052544
    v_add_u32 v192, s60, v192
    v_add_u32 v193, 32768, v192
    s_lshl2_add_u32 s60, s52, s62
    s_lshl_b32 s60, s60, 8
    s_add_u32 s60, s60, 229376
    v_and_b32 v3, 31, v0
    v_lshl_add_u32 v194, v3, 3, s60
    s_lshl_b32 s60, s62, 7
    s_add_u32 s61, s60, 149504
    v_lshl_add_u32 v195, v3, 2, s61
    s_add_u32 s61, s60, 162816
    v_lshl_add_u32 v196, v1, 3, s61
    s_mul_i32 s60, s62, 192
    s_add_u32 s60, s60, 148736
    v_lshl_add_u32 v197, v0, 2, s60
    s_lshl_b32 s60, s50, 5
    s_add_u32 s60, s60, s51
    s_lshl2_add_u32 s60, s60, s62
    s_lshl_b32 s60, s60, 11
    s_add_u32 s60, s60, 1048576
    v_lshl_add_u32 v198, v0, 4, s60
    s_add_u32 m0, s64, 13312
    s_nop 0
    buffer_load_dwordx4 v9, s[28:31], s67 offen  lds
    s_mul_i32 s73, s68, 4608
    s_add_u32 s73, s73, 139520
    s_lshl_b32 s61, s69, 11
    s_add_u32 s71, s73, s61
    s_lshl_b32 s60, s70, 12
    s_add_u32 s61, s61, s60
    s_add_u32 s61, s61, 3145728
    v_lshl_add_u32 v199, v0, 4, s61
    s_xor_b32 s61, s69, 1
    s_lshl1_add_u32 s60, s61, s60
    v_lshl_add_u32 v200, v0, 4, s60
    s_mul_i32 s74, s62, 4160
    s_add_u32 s74, s74, 122880
    s_lshl2_add_u32 s75, s61, s74
    s_add_u32 s75, s75, 28
    v_and_b32 v3, 1, v2
    s_lshl_b32 s60, s69, 1
    v_or_b32 v3, s60, v3
    v_lshlrev_b32 v3, 1, v3
    v_xor_b32 v201, v18, v3
    v_lshlrev_b32 v201, 4, v201
    s_lshl_b32 s61, s56, 7
    s_cmp_ge_u32 s51, 28
    s_cselect_b32 s42, 7, 10
    s_cselect_b32 s61, 0, s61
    s_add_u32 m0, s64, 2048
    s_nop 0
    buffer_load_dwordx4 v10, s[24:27], s67 offen  lds
    v_lshl_add_u32 v201, v17, s42, v201
    s_lshl_b32 s60, s62, 3
    s_lshl_b32 s60, s60, s42
    s_add_u32 s19, s60, s61
    v_add_u32 v201, s19, v201
    s_add_u32 s42, s42, 5
    s_add_u32 s60, s44, 524288
    s_addc_u32 s61, s45, 0
    s_cmp_ge_u32 s51, 28
    s_cselect_b64 s[32:33], s[60:61], s[32:33]
    s_cselect_b32 s34, 176128, s34
    s_lshl2_add_u32 s60, s55, s62
    s_lshl_b32 s61, s60, 7
    s_add_u32 s61, s61, 229376
    v_lshl_add_u32 v204, v1, 3, s61
    s_lshl_b32 s60, s60, 14
    s_lshl_b32 s61, s56, 7
    s_add_u32 s60, s60, s61
    v_add_u32 v202, s60, v16
    v_xor_b32 v203, 64, v202
    v_add_u32 v203, 8192, v203
    s_lshl_b32 s60, s62, 11
    s_add_u32 s60, s60, 131072
    v_lshl_add_u32 v205, v0, 4, s60
    s_add_u32 m0, s64, 14336
    s_nop 0
    buffer_load_dwordx4 v10, s[28:31], s67 offen  lds
    v_and_b32 v3, 3, v0
    v_xor_b32 v3, v3, v2
    v_lshlrev_b32 v3, 4, v3
    v_lshl_add_u32 v206, v17, 12, v3
    v_bfe_u32 v3, v0, 2, 1
    v_lshl_add_u32 v206, v3, 9, v206
    s_lshl2_add_u32 s60, s56, s62
    s_lshl_b32 s60, s60, 16
    s_lshr_b32 s61, s55, 3
    s_lshl_b32 s61, s61, 10
    s_add_u32 s60, s60, s61
    s_and_b32 s61, s55, 7
    s_lshl_b32 s61, s61, 6
    s_add_u32 s60, s60, s61
    s_add_u32 s60, s60, 3145728
    v_add_u32 v206, s60, v206
    v_add_u32 v207, 32768, v206
    s_mul_i32 s60, s68, 8320
    s_add_u32 s18, s60, 122880
    s_lshl_b32 s61, s69, 8
    s_add_u32 s60, s18, s61
    v_and_b32 v3, 1, v1
    v_mul_u32_u24 v208, 4158, v3
    v_lshl_add_u32 v208, v1, 1, v208
    v_lshl_add_u32 v208, v2, 4, v208
    v_add_u32 v208, s60, v208
    s_bfe_u32 s67, s65, 196612
    s_add_u32 s67, s67, s54
    s_and_b32 s67, s67, 7
    s_lshl_b32 s66, s67, 7
    s_mul_i32 s67, s67, 176128
    s_cmp_eq_u32 s53, 15
    s_cselect_b32 s66, 0x40000000, s66
    s_add_u32 m0, s63, 40960
    s_nop 0
    buffer_load_dwordx4 v4, s[4:7], s66 offen  lds
    v_add_u32 v209, 1024, v208
    v_add_u32 v210, 2048, v208
    v_add_u32 v211, 3072, v208
    s_add_u32 s60, s73, s61
    s_add_u32 s17, s60, 4096
    s_add_u32 s60, s60, 480
    v_lshlrev_b32 v3, 1, v1
    v_sub_u32 v3, v2, v3
    v_lshl_add_u32 v212, v3, 4, s60
    s_lshl_b32 s61, s69, 12
    s_add_u32 s60, s18, s61
    v_lshl_add_u32 v213, v0, 4, s60
    s_xor_b32 s61, s61, 4096
    s_add_u32 s60, s18, s61
    v_lshl_add_u32 v214, v0, 4, s60
    v_mov_b32 v19, 0
    v_lshl_add_u32 v3, v0, 2, s17
    ds_write_b32 v3, v19
    s_lshl_b32 s8, s56, 7
    s_lshl_b32 s9, s52, 7
    s_add_u32 s9, s9, 1024
    s_lshr_b32 s60, s55, 1
    s_lshl_b32 s60, s60, 7
    s_add_u32 s60, s60, 1024
    s_cmp_eq_u32 s62, 1
    s_cselect_b32 s60, s9, s60
    s_add_u32 m0, s63, 41984
    s_nop 0
    buffer_load_dwordx4 v5, s[4:7], s66 offen  lds
    s_lshl_b32 s61, s50, 7
    s_cmp_eq_u32 s62, 0
    s_cselect_b32 s10, s61, s60
    s_cselect_b32 s11, 32, 16
    s_cmp_eq_u32 s62, 3
    s_cselect_b32 s10, s38, s10
    s_lshr_b32 s60, s70, 4
    s_lshl1_add_u32 s60, s60, s69
    s_lshl_b32 s60, s60, 7
    s_add_u32 s12, s60, 11264
    s_lshl2_add_u32 s60, s56, s62
    s_lshr_b32 s61, s55, 4
    s_lshl1_add_u32 s60, s60, s61
    s_lshl_b32 s60, s60, 7
    s_add_u32 s13, s60, 11264
    s_sub_u32 s14, s57, 22
    s_cselect_b32 s14, s57, s14
    s_sub_u32 s15, s57, 21
    s_cselect_b32 s15, s57, s15
    s_waitcnt lgkmcnt(0)
    v_lshl_add_u32 v79, v0, 2, s74
    s_lshl_b32 s36, s36, 16
    v_writelane_b32 v19, s36, 7
    s_lshr_b32 s60, 255, s69
    s_mov_b32 exec_lo, s60
    s_mov_b32 exec_hi, 0
    ds_write_b32 v79, v19
    s_mov_b64 exec, -1
    s_add_u32 m0, s63, 43008
    s_nop 0
    buffer_load_dwordx4 v6, s[4:7], s66 offen  lds
    s_and_b32 s60, s70, 1
    s_lshl_b32 s60, s60, 4
    s_lshr_b32 s72, s72, s60
    s_and_b32 s72, s72, 0xffff
    s_cmp_eq_u32 s69, 0
    s_cselect_b32 s72, s72, 0
    v_lshl_add_u32 v3, v2, 3, v1
    v_sub_u32 v3, 15, v3
    v_and_b32 v20, 1, v3
    v_lshlrev_b32 v20, 4, v20
    v_lshlrev_b32 v20, v20, s72
    v_lshrrev_b32 v3, 1, v3
    v_cmp_eq_u32 vcc, 0, v3
    s_nop 1
    v_cndmask_b32 v168, 0, v20, vcc
    v_cmp_eq_u32 vcc, 1, v3
    s_nop 1
    v_cndmask_b32 v169, 0, v20, vcc
    v_cmp_eq_u32 vcc, 2, v3
    s_nop 1
    v_cndmask_b32 v170, 0, v20, vcc
    v_cmp_eq_u32 vcc, 3, v3
    s_nop 1
    v_cndmask_b32 v171, 0, v20, vcc
    s_add_u32 m0, s63, 44032
    s_nop 0
    buffer_load_dwordx4 v7, s[4:7], s66 offen  lds
    s_lshl_b32 s16, s62, 10
    s_add_u32 s60, s16, 81920
    v_lshl_add_u32 v215, v0, 4, s60
    s_add_u32 s60, s51, s50
    s_and_b32 s37, s60, 0
    s_setprio 3
    s_add_u32 m0, s64, 40960
    s_nop 0
    buffer_load_dwordx4 v8, s[24:27], s67 offen  lds
    s_add_u32 m0, s64, 53248
    s_nop 0
    buffer_load_dwordx4 v8, s[28:31], s67 offen  lds
    s_add_u32 m0, s64, 41984
    s_nop 0
    buffer_load_dwordx4 v9, s[24:27], s67 offen  lds
    s_add_u32 m0, s64, 54272
    s_nop 0
    buffer_load_dwordx4 v9, s[28:31], s67 offen  lds
    s_add_u32 m0, s64, 43008
    s_nop 0
    buffer_load_dwordx4 v10, s[24:27], s67 offen  lds
    s_add_u32 m0, s64, 55296
    s_nop 0
    buffer_load_dwordx4 v10, s[28:31], s67 offen  lds
    s_waitcnt vmcnt(10) lgkmcnt(0)
    s_barrier
    ds_read_b128 v[60:63], v191
    ds_read_b128 v[64:67], v191 offset:1024
    ds_read_b128 v[68:71], v190
    s_bfe_u32 s67, s65, 196616
    s_add_u32 s67, s67, s54
    s_and_b32 s67, s67, 7
    s_lshl_b32 s66, s67, 7
    s_mul_i32 s67, s67, 176128
    s_cmp_eq_u32 s53, 15
    s_cselect_b32 s66, 0x40000000, s66
    s_add_u32 m0, s63, 81920
    s_nop 0
    buffer_load_dwordx4 v4, s[4:7], s66 offen  lds
    s_add_u32 m0, s63, 82944
    s_nop 0
    buffer_load_dwordx4 v5, s[4:7], s66 offen  lds
    s_add_u32 m0, s63, 83968
    s_nop 0
    buffer_load_dwordx4 v6, s[4:7], s66 offen  lds
    s_add_u32 m0, s63, 84992
    s_nop 0
    buffer_load_dwordx4 v7, s[4:7], s66 offen  lds
    s_cmp_lg_u32 s43, 0
    s_cbranch_scc1 L_nocs_1
    ds_read_b64_tr_b16 v[32:33], v184 offset:0
    ds_read_b64_tr_b16 v[34:35], v184 offset:768
    ds_read_b64_tr_b16 v[36:37], v184 offset:6144
    ds_read_b64_tr_b16 v[38:39], v184 offset:6912
    ds_read_b64_tr_b16 v[40:41], v185 offset:0
    ds_read_b64_tr_b16 v[42:43], v185 offset:768
    ds_read_b64_tr_b16 v[44:45], v185 offset:6144
    ds_read_b64_tr_b16 v[46:47], v185 offset:6912
    ds_read_b64_tr_b16 v[48:49], v184 offset:64
    ds_read_b64_tr_b16 v[50:51], v184 offset:832
    ds_read_b64_tr_b16 v[52:53], v184 offset:6208
    ds_read_b64_tr_b16 v[54:55], v184 offset:6976
    s_waitcnt lgkmcnt(0)
    v_mfma_f32_16x16x32_bf16 v[20:23], v[32:35], v[72:75], 0
    v_mfma_f32_16x16x32_bf16 v[24:27], v[40:43], v[72:75], 0
    v_mfma_f32_16x16x32_bf16 v[28:31], v[48:51], v[72:75], 0
    v_mfma_f32_16x16x32_bf16 v[20:23], v[36:39], v[72:75], v[20:23]
    v_mfma_f32_16x16x32_bf16 v[24:27], v[44:47], v[72:75], v[24:27]
    v_mfma_f32_16x16x32_bf16 v[28:31], v[52:55], v[72:75], v[28:31]
L_nocs_1:
    s_add_u32 m0, s64, 81920
    s_nop 0
    buffer_load_dwordx4 v8, s[24:27], s67 offen  lds
    s_add_u32 m0, s64, 94208
    s_nop 0
    buffer_load_dwordx4 v8, s[28:31], s67 offen  lds
    s_add_u32 m0, s64, 82944
    s_nop 0
    buffer_load_dwordx4 v9, s[24:27], s67 offen  lds
    s_add_u32 m0, s64, 95232
    s_nop 0
    buffer_load_dwordx4 v9, s[28:31], s67 offen  lds
    s_waitcnt vmcnt(8) lgkmcnt(0)
    s_barrier
    s_add_u32 m0, s64, 83968
    s_nop 0
    buffer_load_dwordx4 v10, s[24:27], s67 offen  lds
    s_add_u32 m0, s64, 96256
    s_nop 0
    buffer_load_dwordx4 v10, s[28:31], s67 offen  lds
    s_cmp_lg_u32 s43, 0
    s_cbranch_scc1 L_nocs_2
    ds_read_b64_tr_b16 v[32:33], v184 offset:40960
    ds_read_b64_tr_b16 v[34:35], v184 offset:41728
    ds_read_b64_tr_b16 v[36:37], v184 offset:47104
    ds_read_b64_tr_b16 v[38:39], v184 offset:47872
    ds_read_b64_tr_b16 v[40:41], v185 offset:40960
    ds_read_b64_tr_b16 v[42:43], v185 offset:41728
    ds_read_b64_tr_b16 v[44:45], v185 offset:47104
    ds_read_b64_tr_b16 v[46:47], v185 offset:47872
    ds_read_b64_tr_b16 v[48:49], v184 offset:41024
    ds_read_b64_tr_b16 v[50:51], v184 offset:41792
    ds_read_b64_tr_b16 v[52:53], v184 offset:47168
    ds_read_b64_tr_b16 v[54:55], v184 offset:47936
    s_waitcnt lgkmcnt(0)
    v_mfma_f32_16x16x32_bf16 v[20:23], v[32:35], v[72:75], v[20:23]
    v_mfma_f32_16x16x32_bf16 v[24:27], v[40:43], v[72:75], v[24:27]
    v_mfma_f32_16x16x32_bf16 v[28:31], v[48:51], v[72:75], v[28:31]
    v_mfma_f32_16x16x32_bf16 v[20:23], v[36:39], v[72:75], v[20:23]
    v_mfma_f32_16x16x32_bf16 v[24:27], v[44:47], v[72:75], v[24:27]
    v_mfma_f32_16x16x32_bf16 v[28:31], v[52:55], v[72:75], v[28:31]
L_nocs_2:
    buffer_store_dwordx4 v[60:63], v192, s[44:47], 0 offen sc1
    buffer_store_dwordx4 v[64:67], v193, s[44:47], 0 offen sc1
    s_mov_b32 exec_lo, 0x00010001
    s_mov_b32 exec_hi, 0x00010001
    s_nop 3
    buffer_store_dwordx4 v[68:71], v189, s[44:47], 0 offen sc1
    buffer_store_dwordx4 v[20:23], v186, s[44:47], 0 offen offset:0 sc1
    buffer_store_dwordx4 v[24:27], v186, s[44:47], 0 offen offset:64 sc1
    buffer_store_dwordx4 v[28:31], v186, s[44:47], 0 offen offset:128 sc1
    s_mov_b64 exec, -1
L_ycls0:
    s_bfe_u32 s67, s65, 196620
    s_add_u32 s67, s67, s54
    s_and_b32 s67, s67, 7
    s_lshl_b32 s66, s67, 7
    s_mul_i32 s67, s67, 176128
    s_cmp_eq_u32 s53, 15
    s_cselect_b32 s66, 0x40000000, s66
    s_add_u32 m0, s63, 0
    s_nop 0
    buffer_load_dwordx4 v4, s[4:7], s66 offen  lds
    s_add_u32 m0, s63, 1024
    s_nop 0
    buffer_load_dwordx4 v5, s[4:7], s66 offen  lds
    s_add_u32 m0, s63, 2048
    s_nop 0
    buffer_load_dwordx4 v6, s[4:7], s66 offen  lds
    s_add_u32 m0, s63, 3072
    s_nop 0
    buffer_load_dwordx4 v7, s[4:7], s66 offen  lds
    s_add_u32 m0, s64, 0
    s_nop 0
    buffer_load_dwordx4 v8, s[24:27], s67 offen  lds
    s_add_u32 m0, s64, 12288
    s_nop 0
    buffer_load_dwordx4 v8, s[28:31], s67 offen  lds
    s_add_u32 m0, s64, 1024
    s_nop 0
    buffer_load_dwordx4 v9, s[24:27], s67 offen  lds
    s_add_u32 m0, s64, 13312
    s_nop 0
    buffer_load_dwordx4 v9, s[28:31], s67 offen  lds
    s_add_u32 m0, s64, 2048
    s_nop 0
    buffer_load_dwordx4 v10, s[24:27], s67 offen  lds
    s_waitcnt vmcnt(15)
    s_barrier
    s_load_dword s58, s[40:41], 0
    s_add_u32 m0, s64, 14336
    s_nop 0
    buffer_load_dwordx4 v10, s[28:31], s67 offen  lds
    s_bfe_u32 s67, s65, 196624
    s_add_u32 s67, s67, s54
    s_and_b32 s67, s67, 7
    s_lshl_b32 s66, s67, 7
    s_mul_i32 s67, s67, 176128
    s_cmp_eq_u32 s53, 15
    s_cselect_b32 s66, 0x40000000, s66
    s_add_u32 m0, s63, 40960
    s_nop 0
    buffer_load_dwordx4 v4, s[4:7], s66 offen  lds
    s_add_u32 m0, s63, 41984
    s_nop 0
    buffer_load_dwordx4 v5, s[4:7], s66 offen  lds
    s_add_u32 m0, s63, 43008
    s_nop 0
    buffer_load_dwordx4 v6, s[4:7], s66 offen  lds
    s_add_u32 m0, s63, 44032
    s_nop 0
    buffer_load_dwordx4 v7, s[4:7], s66 offen  lds
    s_add_u32 m0, s64, 40960
    s_nop 0
    buffer_load_dwordx4 v8, s[24:27], s67 offen  lds
    s_add_u32 m0, s64, 53248
    s_nop 0
    buffer_load_dwordx4 v8, s[28:31], s67 offen  lds
    s_add_u32 m0, s64, 41984
    s_nop 0
    buffer_load_dwordx4 v9, s[24:27], s67 offen  lds
    s_add_u32 m0, s64, 54272
    s_nop 0
    buffer_load_dwordx4 v9, s[28:31], s67 offen  lds
    s_add_u32 m0, s64, 43008
    s_nop 0
    buffer_load_dwordx4 v10, s[24:27], s67 offen  lds
    s_waitcnt vmcnt(9)
    s_barrier
    s_cmp_lg_u32 s62, 0
    s_cbranch_scc1 L_ynosig0
    s_mov_b32 s60, 0
L_ygo0:
    s_waitcnt lgkmcnt(0)
    s_cmp_ge_u32 s58, 16
    s_cbranch_scc1 L_ygook0
    s_load_dword s58, s[40:41], 0 glc
    s_sleep 4
    s_add_u32 s60, s60, 1
    s_cmp_lt_u32 s60, 200000
    s_cbranch_scc1 L_ygo0
L_ygook0:
    s_atomic_add s59, s[44:45], s8
    s_atomic_add s59, s[44:45], s9
    s_atomic_add s59, s[44:45], s38
    s_cmp_lg_u32 s53, 15
    s_cbranch_scc1 L_ynosig0
    s_movk_i32 s36, 21504
    s_atomic_add s59, s[44:45], s36
L_ynosig0:
    s_add_u32 m0, s64, 55296
    s_nop 0
    buffer_load_dwordx4 v10, s[28:31], s67 offen  lds
    s_bfe_u32 s67, s65, 196628
    s_add_u32 s67, s67, s54
    s_and_b32 s67, s67, 7
    s_lshl_b32 s66, s67, 7
    s_mul_i32 s67, s67, 176128
    s_cmp_eq_u32 s53, 15
    s_cselect_b32 s66, 0x40000000, s66
    s_add_u32 m0, s63, 81920
    s_nop 0
    buffer_load_dwordx4 v4, s[4:7], s66 offen  lds
    s_add_u32 m0, s63, 82944
    s_nop 0
    buffer_load_dwordx4 v5, s[4:7], s66 offen  lds
    s_add_u32 m0, s63, 83968
    s_nop 0
    buffer_load_dwordx4 v6, s[4:7], s66 offen  lds
    s_add_u32 m0, s63, 84992
    s_nop 0
    buffer_load_dwordx4 v7, s[4:7], s66 offen  lds
    s_add_u32 m0, s64, 81920
    s_nop 0
    buffer_load_dwordx4 v8, s[24:27], s67 offen  lds
    s_add_u32 m0, s64, 94208
    s_nop 0
    buffer_load_dwordx4 v8, s[28:31], s67 offen  lds
    s_add_u32 m0, s64, 82944
    s_nop 0
    buffer_load_dwordx4 v9, s[24:27], s67 offen  lds
    s_add_u32 m0, s64, 95232
    s_nop 0
    buffer_load_dwordx4 v9, s[28:31], s67 offen  lds
    s_add_u32 m0, s64, 83968
    s_nop 0
    buffer_load_dwordx4 v10, s[24:27], s67 offen  lds
    s_waitcnt vmcnt(9)
    s_barrier
    s_add_u32 m0, s64, 96256
    s_nop 0
    buffer_load_dwordx4 v10, s[28:31], s67 offen  lds
    s_bfe_u32 s67, s65, 196632
    s_add_u32 s67, s67, s54
    s_and_b32 s67, s67, 7
    s_lshl_b32 s66, s67, 7
    s_mul_i32 s67, s67, 176128
    s_cmp_eq_u32 s53, 15
    s_cselect_b32 s66, 0x40000000, s66
    s_add_u32 m0, s63, 0
    s_nop 0
    buffer_load_dwordx4 v4, s[4:7], s66 offen  lds
    s_add_u32 m0, s63, 1024
    s_nop 0
    buffer_load_dwordx4 v5, s[4:7], s66 offen  lds
    s_add_u32 m0, s63, 2048
    s_nop 0
    buffer_load_dwordx4 v6, s[4:7], s66 offen  lds
    s_add_u32 m0, s63, 3072
    s_nop 0
    buffer_load_dwordx4 v7, s[4:7], s66 offen  lds
    s_add_u32 m0, s64, 0
    s_nop 0
    buffer_load_dwordx4 v8, s[24:27], s67 offen  lds
    s_add_u32 m0, s64, 12288
    s_nop 0
    buffer_load_dwordx4 v8, s[28:31], s67 offen  lds
    s_add_u32 m0, s64, 1024
    s_nop 0
    buffer_load_dwordx4 v9, s[24:27], s67 offen  lds
    s_add_u32 m0, s64, 13312
    s_nop 0
    buffer_load_dwordx4 v9, s[28:31], s67 offen  lds
    s_add_u32 m0, s64, 2048
    s_nop 0
    buffer_load_dwordx4 v10, s[24:27], s67 offen  lds
    s_lshl2_add_u32 s60, s51, s62
    s_and_b32 s60, s60, 0x73
    s_cmp_lg_u32 s60, 0x71
    s_cbranch_scc1 L_ynowd0
    s_movk_i32 s36, 21504
    s_waitcnt lgkmcnt(0)
    s_mov_b32 s58, 0
    s_atomic_add s58, s[44:45], s36 glc
    s_mov_b32 vcc_lo, 0
L_sp_3:
    s_waitcnt lgkmcnt(0)
    s_cmp_ge_u32 s58, 16
    s_cbranch_scc1 L_spo_4
    s_sleep 2
    s_mov_b32 s58, 0
    s_atomic_add s58, s[44:45], s36 glc
    s_add_u32 vcc_lo, vcc_lo, 1
    s_cmp_lt_u32 vcc_lo, 200000
    s_cbranch_scc1 L_sp_3
    s_waitcnt lgkmcnt(0)
L_spo_4:
L_ynowd0:
    s_waitcnt vmcnt(9)
    s_barrier
    s_waitcnt lgkmcnt(0)
    s_mov_b32 s58, 0
    s_atomic_add s58, s[44:45], s10 glc
    s_add_u32 m0, s64, 14336
    s_nop 0
    buffer_load_dwordx4 v10, s[28:31], s67 offen  lds
    s_bfe_u32 s67, s65, 196636
    s_add_u32 s67, s67, s54
    s_and_b32 s67, s67, 7
    s_lshl_b32 s66, s67, 7
    s_mul_i32 s67, s67, 176128
    s_cmp_eq_u32 s53, 15
    s_cselect_b32 s66, 0x40000000, s66
    s_add_u32 m0, s63, 40960
    s_nop 0
    buffer_load_dwordx4 v4, s[4:7], s66 offen  lds
    s_add_u32 m0, s63, 41984
    s_nop 0
    buffer_load_dwordx4 v5, s[4:7], s66 offen  lds
    s_add_u32 m0, s63, 43008
    s_nop 0
    buffer_load_dwordx4 v6, s[4:7], s66 offen  lds
    s_add_u32 m0, s63, 44032
    s_nop 0
    buffer_load_dwordx4 v7, s[4:7], s66 offen  lds
    s_add_u32 m0, s64, 40960
    s_nop 0
    buffer_load_dwordx4 v8, s[24:27], s67 offen  lds
    s_add_u32 m0, s64, 53248
    s_nop 0
    buffer_load_dwordx4 v8, s[28:31], s67 offen  lds
    s_add_u32 m0, s64, 41984
    s_nop 0
    buffer_load_dwordx4 v9, s[24:27], s67 offen  lds
    s_add_u32 m0, s64, 54272
    s_nop 0
    buffer_load_dwordx4 v9, s[28:31], s67 offen  lds
    s_add_u32 m0, s64, 43008
    s_nop 0
    buffer_load_dwordx4 v10, s[24:27], s67 offen  lds
    s_add_u32 m0, s64, 55296
    s_nop 0
    buffer_load_dwordx4 v10, s[28:31], s67 offen  lds
    s_mov_b32 vcc_lo, 0
L_sp_5:
    s_waitcnt lgkmcnt(0)
    s_cmp_ge_u32 s58, s11
    s_cbranch_scc1 L_spo_6
    s_sleep 2
    s_mov_b32 s58, 0
    s_atomic_add s58, s[44:45], s10 glc
    s_add_u32 vcc_lo, vcc_lo, 1
    s_cmp_lt_u32 vcc_lo, 200000
    s_cbranch_scc1 L_sp_5
    s_waitcnt lgkmcnt(0)
L_spo_6:
    s_waitcnt vmcnt(10)
    s_barrier
L_yjoin:
    buffer_load_dword v32, v187, s[44:47], 0 offen offset:0 sc1
    buffer_load_dword v33, v187, s[44:47], 0 offen offset:768 sc1
    buffer_load_dword v34, v187, s[44:47], 0 offen offset:1536 sc1
    buffer_load_dword v35, v187, s[44:47], 0 offen offset:2304 sc1
    buffer_load_dword v40, v194, s[44:47], 0 offen sc1
    buffer_load_dwordx2 v[42:43], v204, s[44:47], 0 offen sc1
    s_mov_b32 m0, s71
    s_nop 0
    buffer_load_dwordx4 v198, s[44:47], 0 offen sc1 lds
    buffer_load_dwordx4 v198, s[44:47], 0 offen offset:1024 sc1 lds
    s_waitcnt vmcnt(8)
    ds_write_b32 v14, v13 offset:160
    s_mov_b32 m0, s75
    s_nop 0
    buffer_load_dwordx4 v200, s[20:23], 0 offen offset:0  lds
    s_mov_b32 m0, s75
    s_nop 0
    buffer_load_dwordx4 v200, s[20:23], 0 offen offset:1024  lds
    s_mov_b32 m0, s75
    s_nop 0
    buffer_load_dwordx4 v200, s[20:23], 0 offen offset:2048  lds
    s_mov_b32 m0, s75
    s_nop 0
    buffer_load_dwordx4 v200, s[20:23], 0 offen offset:3072  lds
    buffer_load_dwordx4 v[160:163], v202, s[4:7], 0 offen
    buffer_load_dwordx4 v[164:167], v203, s[4:7], 0 offen
    s_add_u32 s60, s14, 0
    s_sub_u32 s61, s60, 22
    s_cselect_b32 s61, s60, s61
    s_add_u32 s61, s61, 0
    s_add_u32 m0, s16, 81920
    s_lshl_b32 s61, s61, s42
    buffer_load_dwordx4 v201, s[32:35], s61 offen sc1 lds
    s_add_u32 s60, s15, 0
    s_sub_u32 s61, s60, 21
    s_cselect_b32 s61, s60, s61
    s_add_u32 s61, s61, 22
    s_add_u32 m0, s16, 102400
    s_lshl_b32 s61, s61, s42
    buffer_load_dwordx4 v201, s[32:35], s61 offen sc1 lds
    s_add_u32 s60, s14, 1
    s_sub_u32 s61, s60, 22
    s_cselect_b32 s61, s60, s61
    s_add_u32 s61, s61, 0
    s_add_u32 m0, s16, 86016
    s_lshl_b32 s61, s61, s42
    buffer_load_dwordx4 v201, s[32:35], s61 offen sc1 lds
    s_waitcnt vmcnt(11)
    v_add_f32 v32, v32, v33
    v_add_f32 v34, v34, v35
    v_add_f32 v32, v32, v34
    ds_write_b32 v195, v40
    ds_write_b64 v196, v[42:43]
    s_mov_b32 exec_hi, 0xffff
    ds_write_b32 v197, v32
    s_mov_b64 exec, -1
    s_waitcnt lgkmcnt(0)
    ds_write_b32 v14, v13 offset:176
    s_add_u32 s60, s15, 1
    s_sub_u32 s61, s60, 21
    s_cselect_b32 s61, s60, s61
    s_add_u32 s61, s61, 22
    s_add_u32 m0, s16, 106496
    s_lshl_b32 s61, s61, s42
    buffer_load_dwordx4 v201, s[32:35], s61 offen sc1 lds
    s_add_u32 s60, s14, 2
    s_sub_u32 s61, s60, 22
    s_cselect_b32 s61, s60, s61
    s_add_u32 s61, s61, 0
    s_add_u32 m0, s16, 90112
    s_lshl_b32 s61, s61, s42
    buffer_load_dwordx4 v201, s[32:35], s61 offen sc1 lds
    s_add_u32 s60, s15, 2
    s_sub_u32 s61, s60, 21
    s_cselect_b32 s61, s60, s61
    s_add_u32 s61, s61, 22
    s_add_u32 m0, s16, 110592
    s_lshl_b32 s61, s61, s42
    buffer_load_dwordx4 v201, s[32:35], s61 offen sc1 lds
    s_add_u32 s60, s14, 3
    s_sub_u32 s61, s60, 22
    s_cselect_b32 s61, s60, s61
    s_add_u32 s61, s61, 0
    s_add_u32 m0, s16, 94208
    s_lshl_b32 s61, s61, s42
    buffer_load_dwordx4 v201, s[32:35], s61 offen sc1 lds
    s_add_u32 s60, s15, 3
    s_sub_u32 s61, s60, 21
    s_cselect_b32 s61, s60, s61
    s_add_u32 s61, s61, 22
    s_add_u32 m0, s16, 114688
    s_lshl_b32 s61, s61, s42
    buffer_load_dwordx4 v201, s[32:35], s61 offen sc1 lds
    s_add_u32 s60, s14, 4
    s_sub_u32 s61, s60, 22
    s_cselect_b32 s61, s60, s61
    s_add_u32 s61, s61, 0
    s_add_u32 m0, s16, 98304
    s_lshl_b32 s61, s61, s42
    buffer_load_dwordx4 v201, s[32:35], s61 offen sc1 lds
    s_add_u32 s60, s15, 4
    s_sub_u32 s61, s60, 21
    s_cselect_b32 s61, s60, s61
    s_add_u32 s61, s61, 22
    s_add_u32 m0, s16, 118784
    s_lshl_b32 s61, s61, s42
    buffer_load_dwordx4 v201, s[32:35], s61 offen sc1 lds
    s_add_u32 s60, s14, 5
    s_sub_u32 s61, s60, 22
    s_cselect_b32 s61, s60, s61
    s_add_u32 s61, s61, 0
    s_add_u32 m0, s16, 150528
    s_lshl_b32 s61, s61, s42
    buffer_load_dwordx4 v201, s[32:35], s61 offen sc1 lds
    s_add_u32 s60, s15, 5
    s_sub_u32 s61, s60, 21
    s_cselect_b32 s61, s60, s61
    s_add_u32 s61, s61, 22
    s_add_u32 m0, s16, 154624
    s_lshl_b32 s61, s61, s42
    buffer_load_dwordx4 v201, s[32:35], s61 offen sc1 lds
    s_waitcnt vmcnt(14)
    ds_write_b32 v14, v13 offset:48
    s_mov_b32 s60, 0
L_lw_7:
    ds_read_b32 v16, v15 offset:48
    s_add_u32 s60, s60, 1
    s_cmp_gt_u32 s60, 1600000
    s_cbranch_scc1 L_lwo_8
    s_waitcnt lgkmcnt(0)
    v_cmp_eq_u32 vcc, 0, v16
    s_cbranch_vccnz L_lw_7
L_lwo_8:
    s_waitcnt lgkmcnt(0)
    ds_read2_b32 v[32:33], v208 offset0:0 offset1:1
    ds_read2_b32 v[34:35], v208 offset0:2 offset1:3
    ds_read_b128 v[64:67], v212 offset:3584
    ds_read2_b32 v[36:37], v208 offset0:128 offset1:129
    ds_read2_b32 v[38:39], v208 offset0:130 offset1:131
    ds_read_b128 v[68:71], v212 offset:3072
    ds_read2_b32 v[40:41], v209 offset0:0 offset1:1
    ds_read2_b32 v[42:43], v209 offset0:2 offset1:3
    ds_read_b128 v[72:75], v212 offset:2560
    ds_read2_b32 v[44:45], v209 offset0:128 offset1:129
    ds_read2_b32 v[46:47], v209 offset0:130 offset1:131
    ds_read_b128 v[76:79], v212 offset:2048
    ds_read2_b32 v[48:49], v210 offset0:0 offset1:1
    ds_read2_b32 v[50:51], v210 offset0:2 offset1:3
    ds_read_b128 v[80:83], v212 offset:1536
    ds_read2_b32 v[52:53], v210 offset0:128 offset1:129
    ds_read2_b32 v[54:55], v210 offset0:130 offset1:131
    ds_read_b128 v[84:87], v212 offset:1024
    ds_read2_b32 v[56:57], v211 offset0:0 offset1:1
    ds_read2_b32 v[58:59], v211 offset0:2 offset1:3
    ds_read_b128 v[88:91], v212 offset:512
    ds_read2_b32 v[60:61], v211 offset0:128 offset1:129
    ds_read2_b32 v[62:63], v211 offset0:130 offset1:131
    s_waitcnt vmcnt(0)
    ds_write_b32 v14, v13 offset:64
    ds_read_b128 v[92:95], v212 offset:0
    s_waitcnt lgkmcnt(0)
    ds_write_b32 v14, v13 offset:240
    s_setprio 0
    s_mov_b32 s60, 0
    s_branch L_lwe_12
L_lw_10:
    s_sleep 1
L_lwe_12:
    ds_read_b32 v19, v14 offset:128
    s_add_u32 s60, s60, 1
    s_cmp_gt_u32 s60, 1600000
    s_cbranch_scc1 L_lwo_11
    s_waitcnt lgkmcnt(0)
    v_cmp_eq_u32 vcc, 0, v19
    s_cbranch_vccnz L_lw_10
L_lwo_11:
    s_waitcnt lgkmcnt(0)
    s_setprio 2
    v_mfma_f32_16x16x32_bf16 v[224:227], v[168:171], v[64:67], 0
    v_mfma_f32_16x16x32_bf16 v[224:227], v[32:35], v[64:67], v[224:227]
    ds_read2_b32 v[96:97], v208 offset0:16 offset1:17
    v_mfma_f32_16x16x32_bf16 v[228:231], v[168:171], v[68:71], 0
    v_mfma_f32_16x16x32_bf16 v[228:231], v[32:35], v[68:71], v[228:231]
    ds_read2_b32 v[98:99], v208 offset0:18 offset1:19
    v_mfma_f32_16x16x32_bf16 v[228:231], v[36:39], v[64:67], v[228:231]
    ds_read_b128 v[128:131], v212 offset:3648
    v_mfma_f32_16x16x32_bf16 v[232:235], v[168:171], v[72:75], 0
    v_mfma_f32_16x16x32_bf16 v[232:235], v[32:35], v[72:75], v[232:235]
    ds_read2_b32 v[100:101], v208 offset0:144 offset1:145
    v_mfma_f32_16x16x32_bf16 v[232:235], v[36:39], v[68:71], v[232:235]
    ds_read2_b32 v[102:103], v208 offset0:146 offset1:147
    v_mfma_f32_16x16x32_bf16 v[232:235], v[40:43], v[64:67], v[232:235]
    ds_read_b128 v[132:135], v212 offset:3136
    v_mfma_f32_16x16x32_bf16 v[236:239], v[168:171], v[76:79], 0
    v_mfma_f32_16x16x32_bf16 v[236:239], v[32:35], v[76:79], v[236:239]
    ds_read2_b32 v[104:105], v209 offset0:16 offset1:17
    v_mfma_f32_16x16x32_bf16 v[236:239], v[36:39], v[72:75], v[236:239]
    ds_read2_b32 v[106:107], v209 offset0:18 offset1:19
    v_mfma_f32_16x16x32_bf16 v[236:239], v[40:43], v[68:71], v[236:239]
    ds_read_b128 v[136:139], v212 offset:2624
    v_mfma_f32_16x16x32_bf16 v[236:239], v[44:47], v[64:67], v[236:239]
    ds_read2_b32 v[108:109], v209 offset0:144 offset1:145
    v_mfma_f32_16x16x32_bf16 v[240:243], v[168:171], v[80:83], 0
    v_mfma_f32_16x16x32_bf16 v[240:243], v[32:35], v[80:83], v[240:243]
    ds_read2_b32 v[110:111], v209 offset0:146 offset1:147
    v_mfma_f32_16x16x32_bf16 v[240:243], v[36:39], v[76:79], v[240:243]
    ds_read_b128 v[140:143], v212 offset:2112
    v_mfma_f32_16x16x32_bf16 v[240:243], v[40:43], v[72:75], v[240:243]
    ds_read2_b32 v[112:113], v210 offset0:16 offset1:17
    v_mfma_f32_16x16x32_bf16 v[240:243], v[44:47], v[68:71], v[240:243]
    ds_read2_b32 v[114:115], v210 offset0:18 offset1:19
    v_mfma_f32_16x16x32_bf16 v[240:243], v[48:51], v[64:67], v[240:243]
    ds_read_b128 v[144:147], v212 offset:1600
    v_mfma_f32_16x16x32_bf16 v[244:247], v[168:171], v[84:87], 0
    v_mfma_f32_16x16x32_bf16 v[244:247], v[32:35], v[84:87], v[244:247]
    ds_read2_b32 v[116:117], v210 offset0:144 offset1:145
    v_mfma_f32_16x16x32_bf16 v[244:247], v[36:39], v[80:83], v[244:247]
    ds_read2_b32 v[118:119], v210 offset0:146 offset1:147
    v_mfma_f32_16x16x32_bf16 v[244:247], v[40:43], v[76:79], v[244:247]
    ds_read_b128 v[148:151], v212 offset:1088
    v_mfma_f32_16x16x32_bf16 v[244:247], v[44:47], v[72:75], v[244:247]
    ds_read2_b32 v[120:121], v211 offset0:16 offset1:17
    v_mfma_f32_16x16x32_bf16 v[244:247], v[48:51], v[68:71], v[244:247]
    ds_read2_b32 v[122:123], v211 offset0:18 offset1:19
    v_mfma_f32_16x16x32_bf16 v[244:247], v[52:55], v[64:67], v[244:247]
    ds_read_b128 v[152:155], v212 offset:576
    v_mfma_f32_16x16x32_bf16 v[248:251], v[168:171], v[88:91], 0
    v_mfma_f32_16x16x32_bf16 v[248:251], v[32:35], v[88:91], v[248:251]
    ds_read2_b32 v[124:125], v211 offset0:144 offset1:145
    v_mfma_f32_16x16x32_bf16 v[248:251], v[36:39], v[84:87], v[248:251]
    ds_read2_b32 v[126:127], v211 offset0:146 offset1:147
    v_mfma_f32_16x16x32_bf16 v[248:251], v[40:43], v[80:83], v[248:251]
    ds_read_b128 v[156:159], v212 offset:64
    v_mfma_f32_16x16x32_bf16 v[248:251], v[44:47], v[76:79], v[248:251]
    v_mfma_f32_16x16x32_bf16 v[248:251], v[48:51], v[72:75], v[248:251]
    v_mfma_f32_16x16x32_bf16 v[248:251], v[52:55], v[68:71], v[248:251]
    v_mfma_f32_16x16x32_bf16 v[248:251], v[56:59], v[64:67], v[248:251]
    v_mfma_f32_16x16x32_bf16 v[252:255], v[168:171], v[92:95], 0
    v_mfma_f32_16x16x32_bf16 v[252:255], v[32:35], v[92:95], v[252:255]
    v_mfma_f32_16x16x32_bf16 v[252:255], v[36:39], v[88:91], v[252:255]
    v_mfma_f32_16x16x32_bf16 v[252:255], v[40:43], v[84:87], v[252:255]
    v_mfma_f32_16x16x32_bf16 v[252:255], v[44:47], v[80:83], v[252:255]
    v_mfma_f32_16x16x32_bf16 v[252:255], v[48:51], v[76:79], v[252:255]
    v_mfma_f32_16x16x32_bf16 v[252:255], v[52:55], v[72:75], v[252:255]
    v_mfma_f32_16x16x32_bf16 v[252:255], v[56:59], v[68:71], v[252:255]
    v_mfma_f32_16x16x32_bf16 v[252:255], v[60:63], v[64:67], v[252:255]
    s_waitcnt lgkmcnt(0)
    v_mfma_f32_16x16x32_bf16 v[224:227], v[96:99], v[128:131], v[224:227]
    ds_read2_b32 v[32:33], v208 offset0:32 offset1:33
    v_mfma_f32_16x16x32_bf16 v[228:231], v[96:99], v[132:135], v[228:231]
    ds_read2_b32 v[34:35], v208 offset0:34 offset1:35
    v_mfma_f32_16x16x32_bf16 v[228:231], v[100:103], v[128:131], v[228:231]
    ds_read_b128 v[64:67], v212 offset:3712
    v_mfma_f32_16x16x32_bf16 v[232:235], v[96:99], v[136:139], v[232:235]
    ds_read2_b32 v[36:37], v208 offset0:160 offset1:161
    v_mfma_f32_16x16x32_bf16 v[232:235], v[100:103], v[132:135], v[232:235]
    ds_read2_b32 v[38:39], v208 offset0:162 offset1:163
    v_mfma_f32_16x16x32_bf16 v[232:235], v[104:107], v[128:131], v[232:235]
    ds_read_b128 v[68:71], v212 offset:3200
    v_mfma_f32_16x16x32_bf16 v[236:239], v[96:99], v[140:143], v[236:239]
    ds_read2_b32 v[40:41], v209 offset0:32 offset1:33
    v_mfma_f32_16x16x32_bf16 v[236:239], v[100:103], v[136:139], v[236:239]
    ds_read2_b32 v[42:43], v209 offset0:34 offset1:35
    v_mfma_f32_16x16x32_bf16 v[236:239], v[104:107], v[132:135], v[236:239]
    ds_read_b128 v[72:75], v212 offset:2688
    v_mfma_f32_16x16x32_bf16 v[236:239], v[108:111], v[128:131], v[236:239]
    ds_read2_b32 v[44:45], v209 offset0:160 offset1:161
    v_mfma_f32_16x16x32_bf16 v[240:243], v[96:99], v[144:147], v[240:243]
    ds_read2_b32 v[46:47], v209 offset0:162 offset1:163
    v_mfma_f32_16x16x32_bf16 v[240:243], v[100:103], v[140:143], v[240:243]
    ds_read_b128 v[76:79], v212 offset:2176
    v_mfma_f32_16x16x32_bf16 v[240:243], v[104:107], v[136:139], v[240:243]
    ds_read2_b32 v[48:49], v210 offset0:32 offset1:33
    v_mfma_f32_16x16x32_bf16 v[240:243], v[108:111], v[132:135], v[240:243]
    ds_read2_b32 v[50:51], v210 offset0:34 offset1:35
    v_mfma_f32_16x16x32_bf16 v[240:243], v[112:115], v[128:131], v[240:243]
    ds_read_b128 v[80:83], v212 offset:1664
    v_mfma_f32_16x16x32_bf16 v[244:247], v[96:99], v[148:151], v[244:247]
    ds_read2_b32 v[52:53], v210 offset0:160 offset1:161
    v_mfma_f32_16x16x32_bf16 v[244:247], v[100:103], v[144:147], v[244:247]
    ds_read2_b32 v[54:55], v210 offset0:162 offset1:163
    v_mfma_f32_16x16x32_bf16 v[244:247], v[104:107], v[140:143], v[244:247]
    ds_read_b128 v[84:87], v212 offset:1152
    v_mfma_f32_16x16x32_bf16 v[244:247], v[108:111], v[136:139], v[244:247]
    ds_read2_b32 v[56:57], v211 offset0:32 offset1:33
    v_mfma_f32_16x16x32_bf16 v[244:247], v[112:115], v[132:135], v[244:247]
    ds_read2_b32 v[58:59], v211 offset0:34 offset1:35
    v_mfma_f32_16x16x32_bf16 v[244:247], v[116:119], v[128:131], v[244:247]
    ds_read_b128 v[88:91], v212 offset:640
    v_mfma_f32_16x16x32_bf16 v[248:251], v[96:99], v[152:155], v[248:251]
    ds_read2_b32 v[60:61], v211 offset0:160 offset1:161
    v_mfma_f32_16x16x32_bf16 v[248:251], v[100:103], v[148:151], v[248:251]
    ds_read2_b32 v[62:63], v211 offset0:162 offset1:163
    v_mfma_f32_16x16x32_bf16 v[248:251], v[104:107], v[144:147], v[248:251]
    ds_read_b128 v[92:95], v212 offset:128
    v_mfma_f32_16x16x32_bf16 v[248:251], v[108:111], v[140:143], v[248:251]
    v_mfma_f32_16x16x32_bf16 v[248:251], v[112:115], v[136:139], v[248:251]
    v_mfma_f32_16x16x32_bf16 v[248:251], v[116:119], v[132:135], v[248:251]
    v_mfma_f32_16x16x32_bf16 v[248:251], v[120:123], v[128:131], v[248:251]
    v_mfma_f32_16x16x32_bf16 v[252:255], v[96:99], v[156:159], v[252:255]
    v_mfma_f32_16x16x32_bf16 v[252:255], v[100:103], v[152:155], v[252:255]
    v_mfma_f32_16x16x32_bf16 v[252:255], v[104:107], v[148:151], v[252:255]
    v_mfma_f32_16x16x32_bf16 v[252:255], v[108:111], v[144:147], v[252:255]
    v_mfma_f32_16x16x32_bf16 v[252:255], v[112:115], v[140:143], v[252:255]
    v_mfma_f32_16x16x32_bf16 v[252:255], v[116:119], v[136:139], v[252:255]
    v_mfma_f32_16x16x32_bf16 v[252:255], v[120:123], v[132:135], v[252:255]
    v_mfma_f32_16x16x32_bf16 v[252:255], v[124:127], v[128:131], v[252:255]
    s_waitcnt lgkmcnt(0)
    v_mfma_f32_16x16x32_bf16 v[224:227], v[32:35], v[64:67], v[224:227]
    ds_read2_b32 v[96:97], v208 offset0:48 offset1:49
    v_mfma_f32_16x16x32_bf16 v[228:231], v[32:35], v[68:71], v[228:231]
    ds_read2_b32 v[98:99], v208 offset0:50 offset1:51
    v_mfma_f32_16x16x32_bf16 v[228:231], v[36:39], v[64:67], v[228:231]
    ds_read_b128 v[128:131], v212 offset:3776
    v_mfma_f32_16x16x32_bf16 v[232:235], v[32:35], v[72:75], v[232:235]
    ds_read2_b32 v[100:101], v208 offset0:176 offset1:177
    v_mfma_f32_16x16x32_bf16 v[232:235], v[36:39], v[68:71], v[232:235]
    ds_read2_b32 v[102:103], v208 offset0:178 offset1:179
    v_mfma_f32_16x16x32_bf16 v[232:235], v[40:43], v[64:67], v[232:235]
    ds_read_b128 v[132:135], v212 offset:3264
    v_mfma_f32_16x16x32_bf16 v[236:239], v[32:35], v[76:79], v[236:239]
    ds_read2_b32 v[104:105], v209 offset0:48 offset1:49
    v_mfma_f32_16x16x32_bf16 v[236:239], v[36:39], v[72:75], v[236:239]
    ds_read2_b32 v[106:107], v209 offset0:50 offset1:51
    v_mfma_f32_16x16x32_bf16 v[236:239], v[40:43], v[68:71], v[236:239]
    ds_read_b128 v[136:139], v212 offset:2752
    v_mfma_f32_16x16x32_bf16 v[236:239], v[44:47], v[64:67], v[236:239]
    ds_read2_b32 v[108:109], v209 offset0:176 offset1:177
    v_mfma_f32_16x16x32_bf16 v[240:243], v[32:35], v[80:83], v[240:243]
    ds_read2_b32 v[110:111], v209 offset0:178 offset1:179
    v_mfma_f32_16x16x32_bf16 v[240:243], v[36:39], v[76:79], v[240:243]
    ds_read_b128 v[140:143], v212 offset:2240
    v_mfma_f32_16x16x32_bf16 v[240:243], v[40:43], v[72:75], v[240:243]
    ds_read2_b32 v[112:113], v210 offset0:48 offset1:49
    v_mfma_f32_16x16x32_bf16 v[240:243], v[44:47], v[68:71], v[240:243]
    ds_read2_b32 v[114:115], v210 offset0:50 offset1:51
    v_mfma_f32_16x16x32_bf16 v[240:243], v[48:51], v[64:67], v[240:243]
    ds_read_b128 v[144:147], v212 offset:1728
    v_mfma_f32_16x16x32_bf16 v[244:247], v[32:35], v[84:87], v[244:247]
    ds_read2_b32 v[116:117], v210 offset0:176 offset1:177
    v_mfma_f32_16x16x32_bf16 v[244:247], v[36:39], v[80:83], v[244:247]
    ds_read2_b32 v[118:119], v210 offset0:178 offset1:179
    v_mfma_f32_16x16x32_bf16 v[244:247], v[40:43], v[76:79], v[244:247]
    ds_read_b128 v[148:151], v212 offset:1216
    v_mfma_f32_16x16x32_bf16 v[244:247], v[44:47], v[72:75], v[244:247]
    ds_read2_b32 v[120:121], v211 offset0:48 offset1:49
    v_mfma_f32_16x16x32_bf16 v[244:247], v[48:51], v[68:71], v[244:247]
    ds_read2_b32 v[122:123], v211 offset0:50 offset1:51
    v_mfma_f32_16x16x32_bf16 v[244:247], v[52:55], v[64:67], v[244:247]
    ds_read_b128 v[152:155], v212 offset:704
    v_mfma_f32_16x16x32_bf16 v[248:251], v[32:35], v[88:91], v[248:251]
    ds_read2_b32 v[124:125], v211 offset0:176 offset1:177
    v_mfma_f32_16x16x32_bf16 v[248:251], v[36:39], v[84:87], v[248:251]
    ds_read2_b32 v[126:127], v211 offset0:178 offset1:179
    v_mfma_f32_16x16x32_bf16 v[248:251], v[40:43], v[80:83], v[248:251]
    ds_read_b128 v[156:159], v212 offset:192
    v_mfma_f32_16x16x32_bf16 v[248:251], v[44:47], v[76:79], v[248:251]
    v_mfma_f32_16x16x32_bf16 v[248:251], v[48:51], v[72:75], v[248:251]
    v_mfma_f32_16x16x32_bf16 v[248:251], v[52:55], v[68:71], v[248:251]
    v_mfma_f32_16x16x32_bf16 v[248:251], v[56:59], v[64:67], v[248:251]
    v_mfma_f32_16x16x32_bf16 v[252:255], v[32:35], v[92:95], v[252:255]
    v_mfma_f32_16x16x32_bf16 v[252:255], v[36:39], v[88:91], v[252:255]
    v_mfma_f32_16x16x32_bf16 v[252:255], v[40:43], v[84:87], v[252:255]
    v_mfma_f32_16x16x32_bf16 v[252:255], v[44:47], v[80:83], v[252:255]
    v_mfma_f32_16x16x32_bf16 v[252:255], v[48:51], v[76:79], v[252:255]
    v_mfma_f32_16x16x32_bf16 v[252:255], v[52:55], v[72:75], v[252:255]
    v_mfma_f32_16x16x32_bf16 v[252:255], v[56:59], v[68:71], v[252:255]
    v_mfma_f32_16x16x32_bf16 v[252:255], v[60:63], v[64:67], v[252:255]
    s_waitcnt lgkmcnt(0)
    ds_write_b32 v14, v13 offset:80
    s_cmp_eq_u32 s69, 0
    s_cbranch_scc1 L_yl0
    v_mfma_f32_16x16x32_bf16 v[224:227], v[96:99], v[128:131], v[224:227]
    v_mfma_f32_16x16x32_bf16 v[228:231], v[96:99], v[132:135], v[228:231]
    v_mfma_f32_16x16x32_bf16 v[228:231], v[100:103], v[128:131], v[228:231]
    v_mfma_f32_16x16x32_bf16 v[232:235], v[96:99], v[136:139], v[232:235]
    ds_read_b32 v19, v12 offset:80
    v_mfma_f32_16x16x32_bf16 v[232:235], v[100:103], v[132:135], v[232:235]
    v_mfma_f32_16x16x32_bf16 v[232:235], v[104:107], v[128:131], v[232:235]
    v_mfma_f32_16x16x32_bf16 v[236:239], v[96:99], v[140:143], v[236:239]
    s_waitcnt lgkmcnt(0)
    v_cmp_eq_u32 vcc, 0, v19
    v_mfma_f32_16x16x32_bf16 v[236:239], v[100:103], v[136:139], v[236:239]
    s_cbranch_vccz L_yka1
    s_mov_b32 s60, 0
L_lw_13:
    ds_read_b32 v19, v12 offset:80
    s_add_u32 s60, s60, 1
    s_cmp_gt_u32 s60, 1600000
    s_cbranch_scc1 L_lwo_14
    s_waitcnt lgkmcnt(0)
    v_cmp_eq_u32 vcc, 0, v19
    s_cbranch_vccnz L_lw_13
L_lwo_14:
    s_waitcnt lgkmcnt(0)
L_yka1:
    v_mfma_f32_16x16x32_bf16 v[236:239], v[104:107], v[132:135], v[236:239]
    ds_write_b128 v213, v[224:227] offset:0
    v_mfma_f32_16x16x32_bf16 v[236:239], v[108:111], v[128:131], v[236:239]
    v_mfma_f32_16x16x32_bf16 v[240:243], v[96:99], v[144:147], v[240:243]
    ds_write_b128 v213, v[228:231] offset:1024
    v_mfma_f32_16x16x32_bf16 v[240:243], v[100:103], v[140:143], v[240:243]
    v_mfma_f32_16x16x32_bf16 v[240:243], v[104:107], v[136:139], v[240:243]
    v_mfma_f32_16x16x32_bf16 v[240:243], v[108:111], v[132:135], v[240:243]
    ds_write_b128 v213, v[232:235] offset:2048
    v_mfma_f32_16x16x32_bf16 v[240:243], v[112:115], v[128:131], v[240:243]
    v_mfma_f32_16x16x32_bf16 v[244:247], v[96:99], v[148:151], v[244:247]
    v_mfma_f32_16x16x32_bf16 v[244:247], v[100:103], v[144:147], v[244:247]
    v_mfma_f32_16x16x32_bf16 v[244:247], v[104:107], v[140:143], v[244:247]
    ds_write_b128 v213, v[236:239] offset:3072
    v_mfma_f32_16x16x32_bf16 v[244:247], v[108:111], v[136:139], v[244:247]
    v_mfma_f32_16x16x32_bf16 v[244:247], v[112:115], v[132:135], v[244:247]
    v_mfma_f32_16x16x32_bf16 v[244:247], v[116:119], v[128:131], v[244:247]
    v_mfma_f32_16x16x32_bf16 v[248:251], v[96:99], v[152:155], v[248:251]
    v_mfma_f32_16x16x32_bf16 v[248:251], v[100:103], v[148:151], v[248:251]
    v_mfma_f32_16x16x32_bf16 v[248:251], v[104:107], v[144:147], v[248:251]
    v_mfma_f32_16x16x32_bf16 v[248:251], v[108:111], v[140:143], v[248:251]
    v_mfma_f32_16x16x32_bf16 v[248:251], v[112:115], v[136:139], v[248:251]
    v_mfma_f32_16x16x32_bf16 v[248:251], v[116:119], v[132:135], v[248:251]
    v_mfma_f32_16x16x32_bf16 v[248:251], v[120:123], v[128:131], v[248:251]
    v_mfma_f32_16x16x32_bf16 v[252:255], v[96:99], v[156:159], v[252:255]
    v_mfma_f32_16x16x32_bf16 v[252:255], v[100:103], v[152:155], v[252:255]
    v_mfma_f32_16x16x32_bf16 v[252:255], v[104:107], v[148:151], v[252:255]
    v_mfma_f32_16x16x32_bf16 v[252:255], v[108:111], v[144:147], v[252:255]
    v_mfma_f32_16x16x32_bf16 v[252:255], v[112:115], v[140:143], v[252:255]
    v_mfma_f32_16x16x32_bf16 v[252:255], v[116:119], v[136:139], v[252:255]
    v_mfma_f32_16x16x32_bf16 v[252:255], v[120:123], v[132:135], v[252:255]
    v_mfma_f32_16x16x32_bf16 v[252:255], v[124:127], v[128:131], v[252:255]
    s_waitcnt lgkmcnt(0)
    ds_write_b32 v14, v13 offset:96
    s_setprio 2
    s_mov_b32 s60, 0
L_lw_16:
    ds_read_b32 v19, v12 offset:96
    s_add_u32 s60, s60, 1
    s_cmp_gt_u32 s60, 1600000
    s_cbranch_scc1 L_lwo_17
    s_waitcnt lgkmcnt(0)
    v_cmp_eq_u32 vcc, 0, v19
    s_cbranch_vccnz L_lw_16
L_lwo_17:
    s_waitcnt lgkmcnt(0)
    ds_read_b128 v[32:35], v214 offset:0
    ds_read_b128 v[36:39], v214 offset:1024
    ds_read_b128 v[40:43], v214 offset:2048
    ds_read_b128 v[44:47], v214 offset:3072
    s_waitcnt lgkmcnt(3)
    v_add_f32 v32, v240, v32
    v_add_f32 v33, v241, v33
    v_add_f32 v34, v242, v34
    v_add_f32 v35, v243, v35
    s_waitcnt lgkmcnt(2)
    v_add_f32 v36, v244, v36
    v_add_f32 v37, v245, v37
    v_add_f32 v38, v246, v38
    v_add_f32 v39, v247, v39
    s_waitcnt lgkmcnt(1)
    v_add_f32 v40, v248, v40
    v_add_f32 v41, v249, v41
    v_add_f32 v42, v250, v42
    v_add_f32 v43, v251, v43
    s_waitcnt lgkmcnt(0)
    v_add_f32 v44, v252, v44
    v_add_f32 v45, v253, v45
    v_add_f32 v46, v254, v46
    v_add_f32 v47, v255, v47
    s_branch L_ylast
L_yl0:
    v_mfma_f32_16x16x32_bf16 v[252:255], v[96:99], v[156:159], v[252:255]
    v_mfma_f32_16x16x32_bf16 v[252:255], v[100:103], v[152:155], v[252:255]
    v_mfma_f32_16x16x32_bf16 v[252:255], v[104:107], v[148:151], v[252:255]
    v_mfma_f32_16x16x32_bf16 v[252:255], v[108:111], v[144:147], v[252:255]
    ds_read_b32 v19, v12 offset:80
    v_mfma_f32_16x16x32_bf16 v[252:255], v[112:115], v[140:143], v[252:255]
    v_mfma_f32_16x16x32_bf16 v[252:255], v[116:119], v[136:139], v[252:255]
    v_mfma_f32_16x16x32_bf16 v[252:255], v[120:123], v[132:135], v[252:255]
    s_waitcnt lgkmcnt(0)
    v_cmp_eq_u32 vcc, 0, v19
    v_mfma_f32_16x16x32_bf16 v[252:255], v[124:127], v[128:131], v[252:255]
    s_cbranch_vccz L_yka0
    s_mov_b32 s60, 0
L_lw_19:
    ds_read_b32 v19, v12 offset:80
    s_add_u32 s60, s60, 1
    s_cmp_gt_u32 s60, 1600000
    s_cbranch_scc1 L_lwo_20
    s_waitcnt lgkmcnt(0)
    v_cmp_eq_u32 vcc, 0, v19
    s_cbranch_vccnz L_lw_19
L_lwo_20:
    s_waitcnt lgkmcnt(0)
L_yka0:
    v_mfma_f32_16x16x32_bf16 v[248:251], v[96:99], v[152:155], v[248:251]
    v_mfma_f32_16x16x32_bf16 v[248:251], v[100:103], v[148:151], v[248:251]
    v_mfma_f32_16x16x32_bf16 v[248:251], v[104:107], v[144:147], v[248:251]
    v_mfma_f32_16x16x32_bf16 v[248:251], v[108:111], v[140:143], v[248:251]
    v_mfma_f32_16x16x32_bf16 v[248:251], v[112:115], v[136:139], v[248:251]
    v_mfma_f32_16x16x32_bf16 v[248:251], v[116:119], v[132:135], v[248:251]
    v_mfma_f32_16x16x32_bf16 v[248:251], v[120:123], v[128:131], v[248:251]
    v_mfma_f32_16x16x32_bf16 v[244:247], v[96:99], v[148:151], v[244:247]
    ds_write_b128 v213, v[252:255] offset:3072
    v_mfma_f32_16x16x32_bf16 v[244:247], v[100:103], v[144:147], v[244:247]
    v_mfma_f32_16x16x32_bf16 v[244:247], v[104:107], v[140:143], v[244:247]
    v_mfma_f32_16x16x32_bf16 v[244:247], v[108:111], v[136:139], v[244:247]
    v_mfma_f32_16x16x32_bf16 v[244:247], v[112:115], v[132:135], v[244:247]
    v_mfma_f32_16x16x32_bf16 v[244:247], v[116:119], v[128:131], v[244:247]
    v_mfma_f32_16x16x32_bf16 v[240:243], v[96:99], v[144:147], v[240:243]
    v_mfma_f32_16x16x32_bf16 v[240:243], v[100:103], v[140:143], v[240:243]
    ds_write_b128 v213, v[248:251] offset:2048
    v_mfma_f32_16x16x32_bf16 v[240:243], v[104:107], v[136:139], v[240:243]
    v_mfma_f32_16x16x32_bf16 v[240:243], v[108:111], v[132:135], v[240:243]
    v_mfma_f32_16x16x32_bf16 v[240:243], v[112:115], v[128:131], v[240:243]
    v_mfma_f32_16x16x32_bf16 v[236:239], v[96:99], v[140:143], v[236:239]
    v_mfma_f32_16x16x32_bf16 v[236:239], v[100:103], v[136:139], v[236:239]
    v_mfma_f32_16x16x32_bf16 v[236:239], v[104:107], v[132:135], v[236:239]
    ds_write_b128 v213, v[244:247] offset:1024
    v_mfma_f32_16x16x32_bf16 v[236:239], v[108:111], v[128:131], v[236:239]
    v_mfma_f32_16x16x32_bf16 v[232:235], v[96:99], v[136:139], v[232:235]
    v_mfma_f32_16x16x32_bf16 v[232:235], v[100:103], v[132:135], v[232:235]
    v_mfma_f32_16x16x32_bf16 v[232:235], v[104:107], v[128:131], v[232:235]
    v_mfma_f32_16x16x32_bf16 v[228:231], v[96:99], v[132:135], v[228:231]
    ds_write_b128 v213, v[240:243] offset:0
    v_mfma_f32_16x16x32_bf16 v[228:231], v[100:103], v[128:131], v[228:231]
    v_mfma_f32_16x16x32_bf16 v[224:227], v[96:99], v[128:131], v[224:227]
    s_waitcnt lgkmcnt(0)
    ds_write_b32 v14, v13 offset:96
    s_setprio 2
    s_mov_b32 s60, 0
L_lw_22:
    ds_read_b32 v19, v12 offset:96
    s_add_u32 s60, s60, 1
    s_cmp_gt_u32 s60, 1600000
    s_cbranch_scc1 L_lwo_23
    s_waitcnt lgkmcnt(0)
    v_cmp_eq_u32 vcc, 0, v19
    s_cbranch_vccnz L_lw_22
L_lwo_23:
    s_waitcnt lgkmcnt(0)
    ds_read_b128 v[32:35], v214 offset:0
    ds_read_b128 v[36:39], v214 offset:1024
    ds_read_b128 v[40:43], v214 offset:2048
    ds_read_b128 v[44:47], v214 offset:3072
    s_waitcnt lgkmcnt(3)
    v_add_f32 v32, v224, v32
    v_add_f32 v33, v225, v33
    v_add_f32 v34, v226, v34
    v_add_f32 v35, v227, v35
    s_waitcnt lgkmcnt(2)
    v_add_f32 v36, v228, v36
    v_add_f32 v37, v229, v37
    v_add_f32 v38, v230, v38
    v_add_f32 v39, v231, v39
    s_waitcnt lgkmcnt(1)
    v_add_f32 v40, v232, v40
    v_add_f32 v41, v233, v41
    v_add_f32 v42, v234, v42
    v_add_f32 v43, v235, v43
    s_waitcnt lgkmcnt(0)
    v_add_f32 v44, v236, v44
    v_add_f32 v45, v237, v45
    v_add_f32 v46, v238, v46
    v_add_f32 v47, v239, v47
L_ylast:
    ds_write_b32 v14, v13 offset:112
    v_cvt_pk_bf16_f32 v60, v32, v33
    v_cvt_pk_bf16_f32 v61, v34, v35
    v_cvt_pk_bf16_f32 v62, v36, v37
    v_cvt_pk_bf16_f32 v63, v38, v39
    s_nop 1
    v_permlane16_swap_b32 v60, v62
    v_permlane16_swap_b32 v61, v63
    buffer_store_dwordx4 v[60:63], v199, s[44:47], 0 offen offset:0 sc1
    v_cvt_pk_bf16_f32 v64, v40, v41
    v_cvt_pk_bf16_f32 v65, v42, v43
    v_cvt_pk_bf16_f32 v66, v44, v45
    v_cvt_pk_bf16_f32 v67, v46, v47
    s_nop 1
    v_permlane16_swap_b32 v64, v66
    v_permlane16_swap_b32 v65, v67
    buffer_store_dwordx4 v[64:67], v199, s[44:47], 0 offen offset:1024 sc1
    s_mov_b32 s60, 0
L_lw_25:
    ds_read_b32 v16, v15 offset:112
    s_add_u32 s60, s60, 1
    s_cmp_gt_u32 s60, 1600000
    s_cbranch_scc1 L_lwo_26
    s_waitcnt lgkmcnt(0)
    v_cmp_eq_u32 vcc, 0, v16
    s_cbranch_vccnz L_lw_25
L_lwo_26:
    s_waitcnt lgkmcnt(0)
    ds_write_b128 v205, v[160:163]
    ds_write_b128 v205, v[164:167] offset:1024
    s_waitcnt lgkmcnt(0)
    ds_write_b32 v14, v13 offset:192
    s_load_dwordx2 s[36:37], s[0:1], 80
    s_mov_b32 s38, 2097152
    s_mov_b32 s39, 0x20000
    s_lshl2_add_u32 s63, s55, s62
    s_and_b32 s68, s63, 3
    s_lshl_b32 s64, s68, 7
    s_add_u32 s64, s64, 162816
    v_lshl_add_u32 v88, v1, 3, s64
    ds_read_b64 v[88:89], v88
    s_and_b32 s68, s63, 3
    s_mul_i32 s64, s68, 6144
    s_add_u32 s64, s64, 0
    v_lshl_add_u32 v81, v0, 4, s64
    v_lshrrev_b32 v93, 2, v1
    v_lshl_add_u32 v93, v2, 2, v93
    v_bfe_u32 v82, v93, 1, 2
    v_xor_b32 v82, s68, v82
    v_lshlrev_b32 v82, 4, v82
    v_lshl_add_u32 v82, v93, 7, v82
    v_bfe_u32 v93, v1, 1, 1
    v_lshl_add_u32 v82, v93, 6, v82
    v_and_b32 v93, 1, v1
    v_lshl_add_u32 v82, v93, 3, v82
    v_add_u32 v82, 126976, v82
    v_lshrrev_b32 v83, 1, v2
    v_lshrrev_b32 v84, 1, v1
    v_xor_b32 v84, v84, v83
    v_lshlrev_b32 v84, 4, v84
    v_lshl_add_u32 v84, v1, 7, v84
    v_and_b32 v92, 1, v2
    v_lshl_add_u32 v84, v92, 3, v84
    s_lshl_b32 s68, s68, 11
    s_add_u32 s68, s68, 131072
    v_add_u32 v84, s68, v84
    v_xor_b32 v84, 64, v84
    v_xor_b32 v85, 32, v84
    v_lshl_add_u32 v92, v92, 1, v83
    v_bfe_u32 v93, v1, 1, 2
    v_xor_b32 v92, v92, v93
    v_lshlrev_b32 v92, 4, v92
    v_lshl_add_u32 v92, v1, 6, v92
    s_lshl_b32 s68, s3, 10
    s_add_u32 s68, s68, 24576
    v_add_u32 v86, s68, v92
    v_lshl_add_u32 v87, v0, 4, s68
    s_lshl_b32 s64, s63, 14
    s_lshl_b32 s68, s56, 7
    s_add_u32 s64, s64, s68
    s_add_u32 s64, s64, 64
    v_bfe_u32 v93, v0, 3, 2
    v_xor_b32 v93, v93, v0
    v_and_b32 v93, 3, v93
    v_lshl_add_u32 v83, v93, 4, s64
    v_lshrrev_b32 v93, 2, v0
    v_lshl_add_u32 v83, v93, 10, v83
    s_waitcnt lgkmcnt(0)
    v_mul_f32 v91, v89, v89
    v_mul_f32 v90, v91, v89
    v_mul_f32 v91, 0xbfb8aa3b, v91
    s_waitcnt vmcnt(0)
    s_atomic_add s59, s[44:45], s12
    s_mov_b32 s58, 0
    s_atomic_add s58, s[44:45], s13 glc
    s_setprio 0
    s_mov_b32 vcc_lo, 0
L_sp_28:
    s_waitcnt lgkmcnt(0)
    s_cmp_ge_u32 s58, 16
    s_cbranch_scc1 L_spo_29
    s_sleep 2
    s_mov_b32 s58, 0
    s_atomic_add s58, s[44:45], s13 glc
    s_add_u32 vcc_lo, vcc_lo, 1
    s_cmp_lt_u32 vcc_lo, 200000
    s_cbranch_scc1 L_sp_28
    s_waitcnt lgkmcnt(0)
L_spo_29:
    s_mov_b32 s60, 0
    s_branch L_lwe_32
L_lw_30:
    s_sleep 1
L_lwe_32:
    ds_read_b32 v16, v15 offset:208
    s_add_u32 s60, s60, 1
    s_cmp_gt_u32 s60, 1600000
    s_cbranch_scc1 L_lwo_31
    s_waitcnt lgkmcnt(0)
    v_cmp_eq_u32 vcc, 0, v16
    s_cbranch_vccnz L_lw_30
L_lwo_31:
    s_waitcnt lgkmcnt(0)
    s_setprio 2
    s_lshl_b32 s63, s62, 11
    s_add_u32 m0, s63, 122880
    s_nop 0
    buffer_load_dwordx4 v206, s[44:47], 0 offen sc1 lds
    s_add_u32 m0, m0, 1024
    s_nop 0
    buffer_load_dwordx4 v207, s[44:47], 0 offen sc1 lds
    ds_read_b64 v[96:97], v84
    ds_read_b64 v[98:99], v85
    s_waitcnt lgkmcnt(0)
    v_lshlrev_b32 v144, 16, v96
    v_and_b32 v145, 0xffff0000, v96
    v_lshlrev_b32 v146, 16, v97
    v_and_b32 v147, 0xffff0000, v97
    v_lshlrev_b32 v148, 16, v98
    v_and_b32 v149, 0xffff0000, v98
    v_lshlrev_b32 v150, 16, v99
    v_and_b32 v151, 0xffff0000, v99
    v_sub_f32 v152, v144, v88
    v_sub_f32 v153, v145, v88
    v_sub_f32 v154, v146, v88
    v_sub_f32 v155, v147, v88
    v_sub_f32 v156, v148, v88
    v_sub_f32 v157, v149, v88
    v_sub_f32 v158, v150, v88
    v_sub_f32 v159, v151, v88
    v_mul_f32 v152, v152, v90
    v_mul_f32 v153, v153, v90
    v_mul_f32 v154, v154, v90
    v_mul_f32 v155, v155, v90
    v_mul_f32 v156, v156, v90
    v_mul_f32 v157, v157, v90
    v_mul_f32 v158, v158, v90
    v_mul_f32 v159, v159, v90
    s_setprio 1
    s_waitcnt vmcnt(0)
    s_barrier
    ds_read_b128 v[160:163], v81 offset:2048
    ds_read_b128 v[240:243], v81 offset:4096
    ds_read_b128 v[164:167], v81 offset:3072
    ds_read_b128 v[244:247], v81 offset:5120
    s_branch L_final
L_X2:
    s_load_dwordx2 s[44:45], s[0:1], 96
    s_and_b32 s59, s51, 3
    s_mul_i32 s59, s59, 8
    s_and_b32 s59, s59, 63
    s_lshr_b32 s57, s51, 2
    s_mul_i32 s57, s57, 8
    s_add_u32 s57, s57, s59
    s_and_b32 s57, s57, 15
    s_mul_i32 s59, s50, 4
    s_add_u32 s57, s57, s59
    s_and_b32 s57, s57, 31
    s_mul_i32 s57, s57, 11
    s_lshr_b32 s57, s57, 4
    s_mov_b32 s59, 1
    s_mov_b32 s46, 11534336
    s_mov_b32 s47, 0x20000
    s_load_dwordx2 s[32:33], s[0:1], 72
    s_load_dwordx2 s[36:37], s[0:1], 80
    s_load_dwordx2 s[40:41], s[0:1], 88
    s_mov_b32 s34, 1409024
    s_mov_b32 s35, 0x20000
    s_mov_b32 s38, 2097152
    s_mov_b32 s39, 0x20000
    v_mov_b32 v10, 0
    v_lshlrev_b32 v8, 2, v0
    v_add_u32 v8, 150016, v8
    ds_write2st64_b32 v8, v10, v10 offset0:0 offset1:1
    s_cmp_lg_u32 s66, 0
    s_cbranch_scc1 L_nogo
    s_waitcnt vmcnt(22) lgkmcnt(0)
    s_atomic_add s59, s[40:41], 0
L_nogo:
    s_lshl_b32 s61, s3, 1
    s_sub_u32 s61, 7, s61
    v_sub_u32 v8, s61, v2
    v_xor_b32 v8, v8, v1
    v_and_b32 v8, 7, v8
    v_lshlrev_b32 v8, 4, v8
    v_lshl_add_u32 v8, v1, 7, v8
    v_add_u32 v8, 150528, v8
    s_lshl_b32 s64, s3, 4
    s_add_u32 s64, s64, 163328
    v_lshl_add_u32 v9, v2, 3, s64
    s_and_b32 s62, s3, 1
    s_lshr_b32 s63, s3, 1
    s_mul_i32 s64, s63, 3
    v_and_b32 v1, 15, v0
    v_lshrrev_b32 v2, 4, v0
    v_lshrrev_b32 v3, 1, v1
    v_xor_b32 v3, v3, v2
    v_lshlrev_b32 v3, 4, v3
    v_lshl_add_u32 v3, v1, 7, v3
    s_lshl_b32 s60, s62, 13
    v_add_u32 v132, s60, v3
    v_xor_b32 v133, 64, v132
    v_lshrrev_b32 v3, 2, v1
    v_lshl_add_u32 v4, v2, 3, v3
    v_mul_u32_u24 v3, 192, v4
    v_and_b32 v5, 3, v1
    v_lshl_add_u32 v3, v5, 3, v3
    v_add_u32 v3, 16384, v3
    v_and_b32 v6, 1, v2
    s_add_u32 s60, s64, 1
    v_xor_b32 v7, s60, v6
    v_lshl_add_u32 v135, v7, 5, v3
    v_xor_b32 v7, s64, v6
    v_lshl_add_u32 v134, v7, 5, v3
    v_add_u32 v136, 40960, v132
    v_add_u32 v137, 40960, v133
    v_add_u32 v138, 40960, v134
    v_add_u32 v139, 40960, v135
    v_add_u32 v140, 81920, v132
    v_add_u32 v141, 81920, v133
    v_add_u32 v142, 81920, v134
    v_add_u32 v143, 81920, v135
    s_lshl2_add_u32 s60, s3, 150016
    v_mov_b32 v14, s60
    s_xor_b32 s60, s60, 4
    v_mov_b32 v12, s60
    v_and_b32 v15, 3, v0
    v_lshlrev_b32 v15, 2, v15
    v_add_u32 v15, 150016, v15
    v_mov_b32 v13, 1
    s_lshl_b32 s60, s64, 6
    s_add_u32 s60, s60, 148736
    v_lshl_add_u32 v144, v2, 4, s60
    s_lshl_b32 s60, s62, 8
    s_add_u32 s60, s60, 149504
    v_lshl_add_u32 v145, v1, 2, s60
    v_mul_u32_u24 v3, 44032, v6
    v_lshrrev_b32 v7, 1, v2
    v_lshl_add_u32 v3, v7, 8, v3
    v_lshl_add_u32 v3, v1, 4, v3
    s_lshl1_add_u32 s67, s52, s62
    s_mul_i32 s60, s67, 176128
    s_mul_i32 s68, s53, 6
    s_add_u32 s68, s68, s64
    s_lshl_b32 s61, s68, 9
    s_add_u32 s60, s60, s61
    s_add_u32 s60, s60, 5242880
    v_add_u32 v146, s60, v3
    v_add_u32 v147, 88064, v146
    s_lshl_b32 s65, s67, 8
    s_add_u32 s65, s65, 3072
    s_lshl1_add_u32 s66, s53, s63
    s_cmp_eq_u32 s66, 14
    s_cselect_b32 s49, 1, 0
    s_cmp_gt_u32 s66, 28
    s_cselect_b32 s48, 0x80000000, 0
    s_cmp_gt_u32 s66, 14
    s_cselect_b32 s66, 128, 0
    s_add_u32 s65, s65, s66
    s_add_u32 s66, s65, 128
    v_lshlrev_b32 v4, 7, v4
    v_lshl_add_u32 v4, v5, 3, v4
    v_lshlrev_b32 v10, 1, v6
    v_lshrrev_b32 v5, 3, v1
    v_or_b32 v3, v10, v5
    v_lshl_add_u32 v4, v3, 5, v4
    s_mul_i32 s69, s63, 20480
    s_add_u32 s60, s69, 81920
    v_add_u32 v4, s60, v4
    v_xor_b32 v5, 32, v4
    v_xor_b32 v6, 64, v4
    v_xor_b32 v7, 96, v4
    v_and_b32 v3, 7, v0
    v_xor_b32 v3, v3, v10
    v_lshlrev_b32 v3, 4, v3
    v_lshrrev_b32 v10, 3, v0
    s_lshl_b32 s61, s56, 7
    s_cmp_ge_u32 s51, 28
    s_cselect_b32 s30, 7, 10
    s_cselect_b32 s61, 0, s61
    v_lshl_add_u32 v3, v10, s30, v3
    s_lshl_b32 s60, s62, 4
    s_lshl_b32 s60, s60, s30
    s_add_u32 s60, s60, s61
    v_add_u32 v148, s60, v3
    v_xor_b32 v149, 64, v148
    s_lshl_b32 s60, 8, s30
    v_add_u32 v149, s60, v149
    s_sub_u32 s30, s30, 5
    s_lshl1_add_u32 s60, s55, s62
    s_lshl1_add_u32 s75, s60, s63
    s_mul_i32 s61, s60, 88064
    s_add_u32 s61, s61, 5242880
    s_mul_i32 s60, s63, 44032
    s_add_u32 s60, s60, s61
    v_lshl_add_u32 v151, v0, 4, s60
    s_xor_b32 s60, s63, 1
    s_mul_i32 s60, s60, 44032
    s_add_u32 s60, s60, s61
    v_lshl_add_u32 v150, v0, 4, s60
    s_sub_u32 s70, 22, s63
    s_mul_i32 s71, s63, 22
    s_sub_u32 s60, s57, s70
    s_cselect_b32 s72, s57, s60
    s_add_u32 s72, s72, s71
    s_lshl_b32 s8, s72, 10
    s_add_u32 s70, s70, s71
    s_lshl_b32 s70, s70, 10
    s_lshl_b32 s71, s71, 10
    s_add_u32 s9, s8, 1024
    s_cmp_eq_u32 s9, s70
    s_cselect_b32 s9, s71, s9
    s_add_u32 s10, s9, 1024
    s_cmp_eq_u32 s10, s70
    s_cselect_b32 s10, s71, s10
    s_add_u32 s11, s10, 1024
    s_cmp_eq_u32 s11, s70
    s_cselect_b32 s11, s71, s11
    s_add_u32 s12, s11, 1024
    s_cmp_eq_u32 s12, s70
    s_cselect_b32 s12, s71, s12
    s_add_u32 s13, s12, 1024
    s_cmp_eq_u32 s13, s70
    s_cselect_b32 s13, s71, s13
    s_add_u32 s14, s13, 1024
    s_cmp_eq_u32 s14, s70
    s_cselect_b32 s14, s71, s14
    s_add_u32 s15, s14, 1024
    s_cmp_eq_u32 s15, s70
    s_cselect_b32 s15, s71, s15
    s_add_u32 s16, s15, 1024
    s_cmp_eq_u32 s16, s70
    s_cselect_b32 s16, s71, s16
    s_add_u32 s17, s16, 1024
    s_cmp_eq_u32 s17, s70
    s_cselect_b32 s17, s71, s17
    s_add_u32 s18, s17, 1024
    s_cmp_eq_u32 s18, s70
    s_cselect_b32 s18, s71, s18
    s_add_u32 s19, s18, 1024
    s_cmp_eq_u32 s19, s70
    s_cselect_b32 s19, s71, s19
    s_add_u32 s20, s19, 1024
    s_cmp_eq_u32 s20, s70
    s_cselect_b32 s20, s71, s20
    s_add_u32 s21, s20, 1024
    s_cmp_eq_u32 s21, s70
    s_cselect_b32 s21, s71, s21
    s_add_u32 s22, s21, 1024
    s_cmp_eq_u32 s22, s70
    s_cselect_b32 s22, s71, s22
    s_add_u32 s23, s22, 1024
    s_cmp_eq_u32 s23, s70
    s_cselect_b32 s23, s71, s23
    s_add_u32 s24, s23, 1024
    s_cmp_eq_u32 s24, s70
    s_cselect_b32 s24, s71, s24
    s_add_u32 s25, s24, 1024
    s_cmp_eq_u32 s25, s70
    s_cselect_b32 s25, s71, s25
    s_add_u32 s26, s25, 1024
    s_cmp_eq_u32 s26, s70
    s_cselect_b32 s26, s71, s26
    s_add_u32 s27, s26, 1024
    s_cmp_eq_u32 s27, s70
    s_cselect_b32 s27, s71, s27
    s_add_u32 s28, s27, 1024
    s_cmp_eq_u32 s28, s70
    s_cselect_b32 s28, s71, s28
    s_add_u32 s29, s28, 1024
    s_cmp_eq_u32 s29, s70
    s_cselect_b32 s29, s71, s29
    s_cmp_lg_u32 s63, 0
    s_cselect_b32 s29, 0x40000000, s29
    s_lshl_b32 s73, s62, 11
    s_add_u32 s74, s69, s73
    s_lshl_b32 s60, s63, 14
    s_sub_u32 s70, 150528, s60
    s_sub_u32 s71, s70, 81920
    s_sub_u32 s72, 76800, s69
    s_lshl1_add_u32 s67, s55, s63
    s_lshl_b32 s67, s67, 7
    s_add_u32 s67, s67, 3072
    s_mov_b32 s31, 1
    s_cmp_ge_u32 s68, 86
    s_cselect_b32 s31, 0, s31
    s_waitcnt lgkmcnt(0)
    s_cmp_ge_u32 s68, 86
    s_cselect_b32 s40, 0x40000000, 0
    s_cmp_ge_u32 s68, 85
    s_cselect_b32 s41, 0x40000000, 0
    s_cmp_ge_u32 s68, 84
    s_cselect_b32 s42, 0x40000000, 0
    s_lshl_b32 s60, s63, 12
    s_add_u32 s43, s73, s60
    s_mov_b64 s[4:5], s[32:33]
    s_mov_b32 s6, 1409024
    s_add_u32 s60, s44, 524288
    s_addc_u32 s61, s45, 0
    s_cmp_ge_u32 s51, 28
    s_cselect_b64 s[32:33], s[60:61], s[32:33]
    s_cselect_b32 s34, 176128, s34
    s_and_b32 s60, s51, 1
    s_lshl1_add_u32 s60, s50, s60
    s_lshl2_add_u32 s60, s60, s3
    s_mul_i32 s60, s60, 3072
    s_add_u32 s61, s60, 524288
    v_lshl_add_u32 v125, v0, 4, s61
    s_lshl_b32 s61, s56, 7
    s_lshl3_add_u32 s60, s60, s61
    v_and_b32 v124, 7, v0
    v_lshl_add_u32 v124, v124, 4, s60
    v_lshrrev_b32 v126, 3, v0
    v_lshl_add_u32 v124, v126, 10, v124
    s_movk_i32 s60, 8192
    s_movk_i32 s61, 16384
    s_cmp_lg_u32 s53, 15
    s_cbranch_scc1 L_xpack0
    buffer_load_dwordx4 v[112:115], v124, s[4:7], 0 offen
    buffer_load_dwordx4 v[116:119], v124, s[4:7], s60 offen
    buffer_load_dwordx4 v[120:123], v124, s[4:7], s61 offen
L_xpack0:
    s_waitcnt vmcnt(10)
    v_lshlrev_b32 v72, 16, v36
    v_and_b32 v74, 0xffff0000, v36
    v_lshlrev_b32 v76, 16, v37
    v_and_b32 v78, 0xffff0000, v37
    v_lshlrev_b32 v73, 16, v38
    v_and_b32 v75, 0xffff0000, v38
    v_lshlrev_b32 v77, 16, v39
    v_and_b32 v79, 0xffff0000, v39
    v_lshlrev_b32 v48, 16, v16
    v_and_b32 v49, 0xffff0000, v16
    v_lshlrev_b32 v50, 16, v17
    v_and_b32 v51, 0xffff0000, v17
    v_lshlrev_b32 v52, 16, v18
    v_and_b32 v53, 0xffff0000, v18
    v_lshlrev_b32 v54, 16, v19
    v_and_b32 v55, 0xffff0000, v19
    v_lshlrev_b32 v56, 16, v20
    v_and_b32 v57, 0xffff0000, v20
    v_lshlrev_b32 v58, 16, v21
    v_and_b32 v59, 0xffff0000, v21
    v_lshlrev_b32 v60, 16, v22
    v_and_b32 v61, 0xffff0000, v22
    v_lshlrev_b32 v62, 16, v23
    v_and_b32 v63, 0xffff0000, v23
    v_lshlrev_b32 v64, 16, v24
    v_and_b32 v65, 0xffff0000, v24
    v_lshlrev_b32 v66, 16, v25
    v_and_b32 v67, 0xffff0000, v25
    v_lshlrev_b32 v68, 16, v26
    v_and_b32 v69, 0xffff0000, v26
    v_pk_mul_f32 v[96:97], v[48:49], v[78:79]
    v_pk_mul_f32 v[98:99], v[50:51], v[78:79]
    v_pk_mul_f32 v[100:101], v[52:53], v[78:79]
    v_pk_mul_f32 v[102:103], v[54:55], v[78:79]
    v_pk_mul_f32 v[104:105], v[56:57], v[78:79]
    v_pk_mul_f32 v[106:107], v[58:59], v[78:79]
    v_pk_mul_f32 v[108:109], v[60:61], v[78:79]
    v_pk_mul_f32 v[110:111], v[62:63], v[78:79]
    v_pk_fma_f32 v[96:97], v[50:51], v[76:77], v[96:97]
    v_pk_fma_f32 v[98:99], v[52:53], v[76:77], v[98:99]
    v_pk_fma_f32 v[100:101], v[54:55], v[76:77], v[100:101]
    v_pk_fma_f32 v[102:103], v[56:57], v[76:77], v[102:103]
    v_pk_fma_f32 v[104:105], v[58:59], v[76:77], v[104:105]
    v_pk_fma_f32 v[106:107], v[60:61], v[76:77], v[106:107]
    v_pk_fma_f32 v[108:109], v[62:63], v[76:77], v[108:109]
    v_pk_fma_f32 v[110:111], v[64:65], v[76:77], v[110:111]
    v_pk_fma_f32 v[96:97], v[52:53], v[74:75], v[96:97]
    v_pk_fma_f32 v[98:99], v[54:55], v[74:75], v[98:99]
    v_pk_fma_f32 v[100:101], v[56:57], v[74:75], v[100:101]
    v_pk_fma_f32 v[102:103], v[58:59], v[74:75], v[102:103]
    v_pk_fma_f32 v[104:105], v[60:61], v[74:75], v[104:105]
    v_pk_fma_f32 v[106:107], v[62:63], v[74:75], v[106:107]
    v_pk_fma_f32 v[108:109], v[64:65], v[74:75], v[108:109]
    v_pk_fma_f32 v[110:111], v[66:67], v[74:75], v[110:111]
    v_pk_fma_f32 v[96:97], v[54:55], v[72:73], v[96:97]
    v_pk_fma_f32 v[98:99], v[56:57], v[72:73], v[98:99]
    v_pk_fma_f32 v[100:101], v[58:59], v[72:73], v[100:101]
    v_pk_fma_f32 v[102:103], v[60:61], v[72:73], v[102:103]
    v_pk_fma_f32 v[104:105], v[62:63], v[72:73], v[104:105]
    v_pk_fma_f32 v[106:107], v[64:65], v[72:73], v[106:107]
    v_pk_fma_f32 v[108:109], v[66:67], v[72:73], v[108:109]
    v_pk_fma_f32 v[110:111], v[68:69], v[72:73], v[110:111]
    s_waitcnt vmcnt(2)
    v_lshlrev_b32 v80, 16, v28
    v_and_b32 v81, 0xffff0000, v28
    v_lshlrev_b32 v82, 16, v29
    v_and_b32 v83, 0xffff0000, v29
    v_lshlrev_b32 v84, 16, v30
    v_and_b32 v85, 0xffff0000, v30
    v_lshlrev_b32 v86, 16, v31
    v_and_b32 v87, 0xffff0000, v31
    v_lshlrev_b32 v88, 16, v32
    v_and_b32 v89, 0xffff0000, v32
    v_lshlrev_b32 v90, 16, v33
    v_and_b32 v91, 0xffff0000, v33
    v_lshlrev_b32 v92, 16, v34
    v_and_b32 v93, 0xffff0000, v34
    v_lshlrev_b32 v94, 16, v35
    v_and_b32 v95, 0xffff0000, v35
    v_pk_mul_f32 v[96:97], v[96:97], v[80:81]
    v_pk_mul_f32 v[98:99], v[98:99], v[82:83]
    v_pk_mul_f32 v[100:101], v[100:101], v[84:85]
    v_pk_mul_f32 v[102:103], v[102:103], v[86:87]
    v_pk_mul_f32 v[104:105], v[104:105], v[88:89]
    v_pk_mul_f32 v[106:107], v[106:107], v[90:91]
    v_pk_mul_f32 v[108:109], v[108:109], v[92:93]
    v_pk_mul_f32 v[110:111], v[110:111], v[94:95]
    v_cvt_pk_bf16_f32 v16, v110, v108
    v_cvt_pk_bf16_f32 v17, v106, v104
    v_cvt_pk_bf16_f32 v18, v102, v100
    v_cvt_pk_bf16_f32 v19, v98, v96
    ds_write_b128 v8, v[16:19] offset:0
    v_cvt_pk_bf16_f32 v20, v111, v109
    v_cvt_pk_bf16_f32 v21, v107, v105
    v_cvt_pk_bf16_f32 v22, v103, v101
    v_cvt_pk_bf16_f32 v23, v99, v97
    ds_write_b128 v8, v[20:23] offset:4096
    s_waitcnt vmcnt(0)
    v_lshlrev_b32 v48, 16, v40
    v_and_b32 v49, 0xffff0000, v40
    v_lshlrev_b32 v50, 16, v41
    v_and_b32 v51, 0xffff0000, v41
    v_lshlrev_b32 v52, 16, v42
    v_and_b32 v53, 0xffff0000, v42
    v_lshlrev_b32 v54, 16, v43
    v_and_b32 v55, 0xffff0000, v43
    v_lshlrev_b32 v56, 16, v44
    v_and_b32 v57, 0xffff0000, v44
    v_lshlrev_b32 v58, 16, v45
    v_and_b32 v59, 0xffff0000, v45
    v_lshlrev_b32 v60, 16, v46
    v_and_b32 v61, 0xffff0000, v46
    v_lshlrev_b32 v62, 16, v47
    v_and_b32 v63, 0xffff0000, v47
    v_pk_add_f32 v[64:65], v[48:49], v[56:57]
    v_pk_add_f32 v[66:67], v[50:51], v[58:59]
    v_pk_add_f32 v[68:69], v[52:53], v[60:61]
    v_pk_add_f32 v[70:71], v[54:55], v[62:63]
    v_pk_add_f32 v[64:65], v[64:65], v[68:69]
    v_pk_add_f32 v[66:67], v[66:67], v[70:71]
    v_pk_add_f32 v[64:65], v[64:65], v[66:67]
    v_add_f32 v64, v64, v65
    s_nop 1
    v_add_f32_dpp v64, v64, v64 row_ror:8 row_mask:0xf bank_mask:0xf
    s_nop 1
    v_add_f32_dpp v64, v64, v64 row_ror:4 row_mask:0xf bank_mask:0xf
    s_nop 1
    v_add_f32_dpp v64, v64, v64 row_ror:2 row_mask:0xf bank_mask:0xf
    s_nop 1
    v_add_f32_dpp v64, v64, v64 row_ror:1 row_mask:0xf bank_mask:0xf
    s_nop 1
    v_mov_b32 v65, v64
    s_nop 1
    v_permlane16_swap_b32 v64, v65
    v_add_f32 v64, v64, v65
    v_mul_f32 v64, 0x3b000000, v64
    v_pk_add_f32 v[48:49], v[48:49], v[64:65] op_sel_hi:[1,0] neg_lo:[0,1] neg_hi:[0,1]
    v_pk_add_f32 v[50:51], v[50:51], v[64:65] op_sel_hi:[1,0] neg_lo:[0,1] neg_hi:[0,1]
    v_pk_add_f32 v[52:53], v[52:53], v[64:65] op_sel_hi:[1,0] neg_lo:[0,1] neg_hi:[0,1]
    v_pk_add_f32 v[54:55], v[54:55], v[64:65] op_sel_hi:[1,0] neg_lo:[0,1] neg_hi:[0,1]
    v_pk_add_f32 v[56:57], v[56:57], v[64:65] op_sel_hi:[1,0] neg_lo:[0,1] neg_hi:[0,1]
    v_pk_add_f32 v[58:59], v[58:59], v[64:65] op_sel_hi:[1,0] neg_lo:[0,1] neg_hi:[0,1]
    v_pk_add_f32 v[60:61], v[60:61], v[64:65] op_sel_hi:[1,0] neg_lo:[0,1] neg_hi:[0,1]
    v_pk_add_f32 v[62:63], v[62:63], v[64:65] op_sel_hi:[1,0] neg_lo:[0,1] neg_hi:[0,1]
    v_pk_mul_f32 v[66:67], v[48:49], v[48:49]
    v_pk_mul_f32 v[68:69], v[50:51], v[50:51]
    v_pk_fma_f32 v[66:67], v[52:53], v[52:53], v[66:67]
    v_pk_fma_f32 v[68:69], v[54:55], v[54:55], v[68:69]
    v_pk_fma_f32 v[66:67], v[56:57], v[56:57], v[66:67]
    v_pk_fma_f32 v[68:69], v[58:59], v[58:59], v[68:69]
    v_pk_fma_f32 v[66:67], v[60:61], v[60:61], v[66:67]
    v_pk_fma_f32 v[68:69], v[62:63], v[62:63], v[68:69]
    v_pk_add_f32 v[66:67], v[66:67], v[68:69]
    v_add_f32 v66, v66, v67
    s_nop 1
    v_add_f32_dpp v66, v66, v66 row_ror:8 row_mask:0xf bank_mask:0xf
    s_nop 1
    v_add_f32_dpp v66, v66, v66 row_ror:4 row_mask:0xf bank_mask:0xf
    s_nop 1
    v_add_f32_dpp v66, v66, v66 row_ror:2 row_mask:0xf bank_mask:0xf
    s_nop 1
    v_add_f32_dpp v66, v66, v66 row_ror:1 row_mask:0xf bank_mask:0xf
    s_nop 1
    v_mov_b32 v67, v66
    s_nop 1
    v_permlane16_swap_b32 v66, v67
    v_add_f32 v66, v66, v67
    v_mul_f32 v66, 0x3b000000, v66
    v_cvt_pk_bf16_f32 v66, v64, v66
    v_lshlrev_b32 v64, 16, v66
    v_and_b32 v66, 0xffff0000, v66
    v_add_f32 v66, 0x3727c5ac, v66
    v_cvt_pk_bf16_f32 v66, v66, v66
    v_and_b32 v66, 0xffff0000, v66
    v_sqrt_f32 v66, v66
    s_nop 0
    v_cvt_pk_bf16_f32 v66, v66, v66
    v_and_b32 v66, 0xffff0000, v66
    v_rcp_f32 v65, v66
    s_nop 0
    ds_write_b64 v9, v[64:65]
    s_waitcnt lgkmcnt(0)
    v_mov_b32 v8, v148
    v_mov_b32 v9, v149
    v_mov_b32 v10, v150
    v_mov_b32 v11, v151
    s_setprio 1
    s_waitcnt lgkmcnt(0)
    s_barrier
    s_cmp_ge_u32 s68, 86
    s_cbranch_scc1 L_xidle
    ds_read_b64_tr_b16 v[80:81], v134 offset:0
    ds_read_b64_tr_b16 v[82:83], v134 offset:768
    ds_read_b64_tr_b16 v[84:85], v134 offset:6144
    ds_read_b64_tr_b16 v[86:87], v134 offset:6912
    ds_read_b128 v[16:19], v132 offset:0
    ds_read_b128 v[20:23], v133 offset:0
    ds_read_b128 v[24:27], v132 offset:2048
    ds_read_b128 v[28:31], v133 offset:2048
    ds_read_b128 v[32:35], v132 offset:4096
    ds_read_b128 v[36:39], v133 offset:4096
    ds_read_b128 v[40:43], v132 offset:6144
    ds_read_b128 v[44:47], v133 offset:6144
    s_waitcnt lgkmcnt(4)
    v_mfma_f32_16x16x32_bf16 v[160:163], v[80:83], v[16:19], 0
    ds_read_b64_tr_b16 v[88:89], v134 offset:12288
    v_mfma_f32_16x16x32_bf16 v[160:163], v[84:87], v[20:23], v[160:163]
    ds_read_b64_tr_b16 v[90:91], v134 offset:13056
    v_mfma_f32_16x16x32_bf16 v[164:167], v[84:87], v[28:31], 0
    ds_read_b64_tr_b16 v[92:93], v134 offset:18432
    v_mfma_f32_16x16x32_bf16 v[164:167], v[80:83], v[24:27], v[164:167]
    ds_read_b64_tr_b16 v[94:95], v134 offset:19200
    s_waitcnt lgkmcnt(4)
    v_mfma_f32_16x16x32_bf16 v[168:171], v[80:83], v[32:35], 0
    ds_read_b64_tr_b16 v[96:97], v135 offset:0
    v_mfma_f32_16x16x32_bf16 v[168:171], v[84:87], v[36:39], v[168:171]
    ds_read_b64_tr_b16 v[98:99], v135 offset:768
    v_mfma_f32_16x16x32_bf16 v[172:175], v[84:87], v[44:47], 0
    ds_read_b64_tr_b16 v[100:101], v135 offset:6144
    v_mfma_f32_16x16x32_bf16 v[172:175], v[80:83], v[40:43], v[172:175]
    ds_read_b64_tr_b16 v[102:103], v135 offset:6912
    s_waitcnt lgkmcnt(4)
    v_mfma_f32_16x16x32_bf16 v[188:191], v[88:91], v[40:43], 0
    ds_read_b64_tr_b16 v[152:153], v135 offset:12288
    v_mfma_f32_16x16x32_bf16 v[188:191], v[92:95], v[44:47], v[188:191]
    ds_read_b64_tr_b16 v[154:155], v135 offset:13056
    v_mfma_f32_16x16x32_bf16 v[184:187], v[92:95], v[36:39], 0
    ds_read_b64_tr_b16 v[156:157], v135 offset:18432
    v_mfma_f32_16x16x32_bf16 v[184:187], v[88:91], v[32:35], v[184:187]
    ds_read_b64_tr_b16 v[158:159], v135 offset:19200
    v_mfma_f32_16x16x32_bf16 v[180:183], v[88:91], v[24:27], 0
    ds_read_b64_tr_b16 v[80:81], v134 offset:64
    v_mfma_f32_16x16x32_bf16 v[180:183], v[92:95], v[28:31], v[180:183]
    ds_read_b64_tr_b16 v[82:83], v134 offset:832
    v_mfma_f32_16x16x32_bf16 v[176:179], v[92:95], v[20:23], 0
    ds_read_b64_tr_b16 v[84:85], v134 offset:6208
    v_mfma_f32_16x16x32_bf16 v[176:179], v[88:91], v[16:19], v[176:179]
    ds_read_b64_tr_b16 v[86:87], v134 offset:6976
    s_waitcnt lgkmcnt(8)
    v_mfma_f32_16x16x32_bf16 v[192:195], v[96:99], v[16:19], 0
    ds_read_b64_tr_b16 v[88:89], v134 offset:12352
    v_mfma_f32_16x16x32_bf16 v[192:195], v[100:103], v[20:23], v[192:195]
    ds_read_b64_tr_b16 v[90:91], v134 offset:13120
    v_mfma_f32_16x16x32_bf16 v[196:199], v[100:103], v[28:31], 0
    ds_read_b64_tr_b16 v[92:93], v134 offset:18496
    v_mfma_f32_16x16x32_bf16 v[196:199], v[96:99], v[24:27], v[196:199]
    ds_read_b64_tr_b16 v[94:95], v134 offset:19264
    v_mfma_f32_16x16x32_bf16 v[200:203], v[96:99], v[32:35], 0
    v_mfma_f32_16x16x32_bf16 v[200:203], v[100:103], v[36:39], v[200:203]
    v_mfma_f32_16x16x32_bf16 v[204:207], v[100:103], v[44:47], 0
    v_mfma_f32_16x16x32_bf16 v[204:207], v[96:99], v[40:43], v[204:207]
    s_waitcnt lgkmcnt(8)
    v_mfma_f32_16x16x32_bf16 v[220:223], v[152:155], v[40:43], 0
    v_mfma_f32_16x16x32_bf16 v[220:223], v[156:159], v[44:47], v[220:223]
    s_waitcnt lgkmcnt(0)
    s_barrier
    v_mfma_f32_16x16x32_bf16 v[216:219], v[156:159], v[36:39], 0
    ds_read_b64_tr_b16 v[96:97], v138 offset:0
    v_mfma_f32_16x16x32_bf16 v[216:219], v[152:155], v[32:35], v[216:219]
    ds_read_b64_tr_b16 v[98:99], v138 offset:768
    v_mfma_f32_16x16x32_bf16 v[212:215], v[152:155], v[24:27], 0
    ds_read_b64_tr_b16 v[100:101], v138 offset:6144
    v_mfma_f32_16x16x32_bf16 v[212:215], v[156:159], v[28:31], v[212:215]
    ds_read_b64_tr_b16 v[102:103], v138 offset:6912
    v_mfma_f32_16x16x32_bf16 v[208:211], v[156:159], v[20:23], 0
    ds_read_b128 v[48:51], v136 offset:0
    v_mfma_f32_16x16x32_bf16 v[208:211], v[152:155], v[16:19], v[208:211]
    ds_read_b128 v[52:55], v137 offset:0
    v_mfma_f32_16x16x32_bf16 v[224:227], v[80:83], v[16:19], 0
    ds_read_b128 v[56:59], v136 offset:2048
    v_mfma_f32_16x16x32_bf16 v[224:227], v[84:87], v[20:23], v[224:227]
    ds_read_b128 v[60:63], v137 offset:2048
    v_mfma_f32_16x16x32_bf16 v[228:231], v[84:87], v[28:31], 0
    ds_read_b128 v[64:67], v136 offset:4096
    v_mfma_f32_16x16x32_bf16 v[228:231], v[80:83], v[24:27], v[228:231]
    ds_read_b128 v[68:71], v137 offset:4096
    v_mfma_f32_16x16x32_bf16 v[232:235], v[80:83], v[32:35], 0
    ds_read_b128 v[72:75], v136 offset:6144
    v_mfma_f32_16x16x32_bf16 v[232:235], v[84:87], v[36:39], v[232:235]
    ds_read_b128 v[76:79], v137 offset:6144
    v_mfma_f32_16x16x32_bf16 v[236:239], v[84:87], v[44:47], 0
    ds_read_b64_tr_b16 v[152:153], v138 offset:12288
    v_mfma_f32_16x16x32_bf16 v[236:239], v[80:83], v[40:43], v[236:239]
    ds_read_b64_tr_b16 v[154:155], v138 offset:13056
    v_mfma_f32_16x16x32_bf16 v[252:255], v[88:91], v[40:43], 0
    ds_read_b64_tr_b16 v[156:157], v138 offset:18432
    v_mfma_f32_16x16x32_bf16 v[252:255], v[92:95], v[44:47], v[252:255]
    ds_read_b64_tr_b16 v[158:159], v138 offset:19200
    v_mfma_f32_16x16x32_bf16 v[248:251], v[92:95], v[36:39], 0
    ds_read_b64_tr_b16 v[80:81], v139 offset:0
    v_mfma_f32_16x16x32_bf16 v[248:251], v[88:91], v[32:35], v[248:251]
    ds_read_b64_tr_b16 v[82:83], v139 offset:768
    v_mfma_f32_16x16x32_bf16 v[244:247], v[88:91], v[24:27], 0
    ds_read_b64_tr_b16 v[84:85], v139 offset:6144
    v_mfma_f32_16x16x32_bf16 v[244:247], v[92:95], v[28:31], v[244:247]
    ds_read_b64_tr_b16 v[86:87], v139 offset:6912
    v_mfma_f32_16x16x32_bf16 v[240:243], v[92:95], v[20:23], 0
    v_mfma_f32_16x16x32_bf16 v[240:243], v[88:91], v[16:19], v[240:243]
    ds_read_b64_tr_b16 v[88:89], v139 offset:12288
    s_waitcnt lgkmcnt(13)
    v_mfma_f32_16x16x32_bf16 v[160:163], v[96:99], v[48:51], v[160:163]
    ds_read_b64_tr_b16 v[90:91], v139 offset:13056
    v_mfma_f32_16x16x32_bf16 v[160:163], v[100:103], v[52:55], v[160:163]
    ds_read_b64_tr_b16 v[92:93], v139 offset:18432
    v_mfma_f32_16x16x32_bf16 v[164:167], v[100:103], v[60:63], v[164:167]
    ds_read_b64_tr_b16 v[94:95], v139 offset:19200
    v_mfma_f32_16x16x32_bf16 v[164:167], v[96:99], v[56:59], v[164:167]
    s_waitcnt lgkmcnt(12)
    v_mfma_f32_16x16x32_bf16 v[168:171], v[96:99], v[64:67], v[168:171]
    v_mfma_f32_16x16x32_bf16 v[168:171], v[100:103], v[68:71], v[168:171]
    v_mfma_f32_16x16x32_bf16 v[172:175], v[100:103], v[76:79], v[172:175]
    v_mfma_f32_16x16x32_bf16 v[172:175], v[96:99], v[72:75], v[172:175]
    ds_read_b64_tr_b16 v[96:97], v138 offset:64
    s_waitcnt lgkmcnt(9)
    v_mfma_f32_16x16x32_bf16 v[188:191], v[152:155], v[72:75], v[188:191]
    ds_read_b64_tr_b16 v[98:99], v138 offset:832
    v_mfma_f32_16x16x32_bf16 v[188:191], v[156:159], v[76:79], v[188:191]
    ds_read_b64_tr_b16 v[100:101], v138 offset:6208
    v_mfma_f32_16x16x32_bf16 v[184:187], v[156:159], v[68:71], v[184:187]
    ds_read_b64_tr_b16 v[102:103], v138 offset:6976
    v_mfma_f32_16x16x32_bf16 v[184:187], v[152:155], v[64:67], v[184:187]
    v_mfma_f32_16x16x32_bf16 v[180:183], v[152:155], v[56:59], v[180:183]
    v_mfma_f32_16x16x32_bf16 v[180:183], v[156:159], v[60:63], v[180:183]
    v_mfma_f32_16x16x32_bf16 v[176:179], v[156:159], v[52:55], v[176:179]
    v_mfma_f32_16x16x32_bf16 v[176:179], v[152:155], v[48:51], v[176:179]
    ds_read_b64_tr_b16 v[152:153], v138 offset:12352
    s_waitcnt lgkmcnt(9)
    v_mfma_f32_16x16x32_bf16 v[192:195], v[80:83], v[48:51], v[192:195]
    ds_read_b64_tr_b16 v[154:155], v138 offset:13120
    v_mfma_f32_16x16x32_bf16 v[192:195], v[84:87], v[52:55], v[192:195]
    ds_read_b64_tr_b16 v[156:157], v138 offset:18496
    v_mfma_f32_16x16x32_bf16 v[196:199], v[84:87], v[60:63], v[196:199]
    ds_read_b64_tr_b16 v[158:159], v138 offset:19264
    v_mfma_f32_16x16x32_bf16 v[196:199], v[80:83], v[56:59], v[196:199]
    v_mfma_f32_16x16x32_bf16 v[200:203], v[80:83], v[64:67], v[200:203]
    v_mfma_f32_16x16x32_bf16 v[200:203], v[84:87], v[68:71], v[200:203]
    v_mfma_f32_16x16x32_bf16 v[204:207], v[84:87], v[76:79], v[204:207]
    v_mfma_f32_16x16x32_bf16 v[204:207], v[80:83], v[72:75], v[204:207]
    s_waitcnt lgkmcnt(8)
    v_mfma_f32_16x16x32_bf16 v[220:223], v[88:91], v[72:75], v[220:223]
    v_mfma_f32_16x16x32_bf16 v[220:223], v[92:95], v[76:79], v[220:223]
    s_waitcnt lgkmcnt(0)
    s_barrier
    v_mfma_f32_16x16x32_bf16 v[216:219], v[92:95], v[68:71], v[216:219]
    ds_read_b64_tr_b16 v[80:81], v142 offset:0
    v_mfma_f32_16x16x32_bf16 v[216:219], v[88:91], v[64:67], v[216:219]
    ds_read_b64_tr_b16 v[82:83], v142 offset:768
    v_mfma_f32_16x16x32_bf16 v[212:215], v[88:91], v[56:59], v[212:215]
    ds_read_b64_tr_b16 v[84:85], v142 offset:6144
    v_mfma_f32_16x16x32_bf16 v[212:215], v[92:95], v[60:63], v[212:215]
    ds_read_b64_tr_b16 v[86:87], v142 offset:6912
    v_mfma_f32_16x16x32_bf16 v[208:211], v[92:95], v[52:55], v[208:211]
    ds_read_b128 v[16:19], v140 offset:0
    v_mfma_f32_16x16x32_bf16 v[208:211], v[88:91], v[48:51], v[208:211]
    ds_read_b128 v[20:23], v141 offset:0
    v_mfma_f32_16x16x32_bf16 v[224:227], v[96:99], v[48:51], v[224:227]
    ds_read_b128 v[24:27], v140 offset:2048
    v_mfma_f32_16x16x32_bf16 v[224:227], v[100:103], v[52:55], v[224:227]
    ds_read_b128 v[28:31], v141 offset:2048
    v_mfma_f32_16x16x32_bf16 v[228:231], v[100:103], v[60:63], v[228:231]
    ds_read_b128 v[32:35], v140 offset:4096
    v_mfma_f32_16x16x32_bf16 v[228:231], v[96:99], v[56:59], v[228:231]
    ds_read_b128 v[36:39], v141 offset:4096
    v_mfma_f32_16x16x32_bf16 v[232:235], v[96:99], v[64:67], v[232:235]
    ds_read_b128 v[40:43], v140 offset:6144
    v_mfma_f32_16x16x32_bf16 v[232:235], v[100:103], v[68:71], v[232:235]
    ds_read_b128 v[44:47], v141 offset:6144
    v_mfma_f32_16x16x32_bf16 v[236:239], v[100:103], v[76:79], v[236:239]
    ds_read_b64_tr_b16 v[88:89], v142 offset:12288
    v_mfma_f32_16x16x32_bf16 v[236:239], v[96:99], v[72:75], v[236:239]
    ds_read_b64_tr_b16 v[90:91], v142 offset:13056
    v_mfma_f32_16x16x32_bf16 v[252:255], v[152:155], v[72:75], v[252:255]
    ds_read_b64_tr_b16 v[92:93], v142 offset:18432
    v_mfma_f32_16x16x32_bf16 v[252:255], v[156:159], v[76:79], v[252:255]
    ds_read_b64_tr_b16 v[94:95], v142 offset:19200
    v_mfma_f32_16x16x32_bf16 v[248:251], v[156:159], v[68:71], v[248:251]
    ds_read_b64_tr_b16 v[96:97], v143 offset:0
    v_mfma_f32_16x16x32_bf16 v[248:251], v[152:155], v[64:67], v[248:251]
    ds_read_b64_tr_b16 v[98:99], v143 offset:768
    v_mfma_f32_16x16x32_bf16 v[244:247], v[152:155], v[56:59], v[244:247]
    ds_read_b64_tr_b16 v[100:101], v143 offset:6144
    v_mfma_f32_16x16x32_bf16 v[244:247], v[156:159], v[60:63], v[244:247]
    ds_read_b64_tr_b16 v[102:103], v143 offset:6912
    v_mfma_f32_16x16x32_bf16 v[240:243], v[156:159], v[52:55], v[240:243]
    v_mfma_f32_16x16x32_bf16 v[240:243], v[152:155], v[48:51], v[240:243]
    ds_read_b64_tr_b16 v[152:153], v143 offset:12288
    s_waitcnt lgkmcnt(13)
    v_mfma_f32_16x16x32_bf16 v[160:163], v[80:83], v[16:19], v[160:163]
    ds_read_b64_tr_b16 v[154:155], v143 offset:13056
    v_mfma_f32_16x16x32_bf16 v[160:163], v[84:87], v[20:23], v[160:163]
    ds_read_b64_tr_b16 v[156:157], v143 offset:18432
    v_mfma_f32_16x16x32_bf16 v[164:167], v[84:87], v[28:31], v[164:167]
    ds_read_b64_tr_b16 v[158:159], v143 offset:19200
    v_mfma_f32_16x16x32_bf16 v[164:167], v[80:83], v[24:27], v[164:167]
    s_waitcnt lgkmcnt(12)
    v_mfma_f32_16x16x32_bf16 v[168:171], v[80:83], v[32:35], v[168:171]
    v_mfma_f32_16x16x32_bf16 v[168:171], v[84:87], v[36:39], v[168:171]
    v_mfma_f32_16x16x32_bf16 v[172:175], v[84:87], v[44:47], v[172:175]
    v_mfma_f32_16x16x32_bf16 v[172:175], v[80:83], v[40:43], v[172:175]
    ds_read_b64_tr_b16 v[80:81], v142 offset:64
    s_waitcnt lgkmcnt(9)
    v_mfma_f32_16x16x32_bf16 v[188:191], v[88:91], v[40:43], v[188:191]
    ds_read_b64_tr_b16 v[82:83], v142 offset:832
    v_mfma_f32_16x16x32_bf16 v[188:191], v[92:95], v[44:47], v[188:191]
    ds_read_b64_tr_b16 v[84:85], v142 offset:6208
    v_mfma_f32_16x16x32_bf16 v[184:187], v[92:95], v[36:39], v[184:187]
    ds_read_b64_tr_b16 v[86:87], v142 offset:6976
    v_mfma_f32_16x16x32_bf16 v[184:187], v[88:91], v[32:35], v[184:187]
    v_mfma_f32_16x16x32_bf16 v[180:183], v[88:91], v[24:27], v[180:183]
    v_mfma_f32_16x16x32_bf16 v[180:183], v[92:95], v[28:31], v[180:183]
    v_mfma_f32_16x16x32_bf16 v[176:179], v[92:95], v[20:23], v[176:179]
    v_mfma_f32_16x16x32_bf16 v[176:179], v[88:91], v[16:19], v[176:179]
    ds_read_b64_tr_b16 v[88:89], v142 offset:12352
    s_waitcnt lgkmcnt(9)
    v_mfma_f32_16x16x32_bf16 v[192:195], v[96:99], v[16:19], v[192:195]
    ds_read_b64_tr_b16 v[90:91], v142 offset:13120
    v_mfma_f32_16x16x32_bf16 v[192:195], v[100:103], v[20:23], v[192:195]
    ds_read_b64_tr_b16 v[92:93], v142 offset:18496
    v_mfma_f32_16x16x32_bf16 v[196:199], v[100:103], v[28:31], v[196:199]
    ds_read_b64_tr_b16 v[94:95], v142 offset:19264
    v_mfma_f32_16x16x32_bf16 v[196:199], v[96:99], v[24:27], v[196:199]
    v_mfma_f32_16x16x32_bf16 v[200:203], v[96:99], v[32:35], v[200:203]
    v_mfma_f32_16x16x32_bf16 v[200:203], v[100:103], v[36:39], v[200:203]
    v_mfma_f32_16x16x32_bf16 v[204:207], v[100:103], v[44:47], v[204:207]
    v_mfma_f32_16x16x32_bf16 v[204:207], v[96:99], v[40:43], v[204:207]
    s_waitcnt lgkmcnt(8)
    v_mfma_f32_16x16x32_bf16 v[220:223], v[152:155], v[40:43], v[220:223]
    v_mfma_f32_16x16x32_bf16 v[220:223], v[156:159], v[44:47], v[220:223]
    s_waitcnt lgkmcnt(0)
    s_barrier
    v_mfma_f32_16x16x32_bf16 v[216:219], v[156:159], v[36:39], v[216:219]
    ds_read_b64_tr_b16 v[96:97], v134 offset:0
    v_mfma_f32_16x16x32_bf16 v[216:219], v[152:155], v[32:35], v[216:219]
    ds_read_b64_tr_b16 v[98:99], v134 offset:768
    v_mfma_f32_16x16x32_bf16 v[212:215], v[152:155], v[24:27], v[212:215]
    ds_read_b64_tr_b16 v[100:101], v134 offset:6144
    v_mfma_f32_16x16x32_bf16 v[212:215], v[156:159], v[28:31], v[212:215]
    ds_read_b64_tr_b16 v[102:103], v134 offset:6912
    v_mfma_f32_16x16x32_bf16 v[208:211], v[156:159], v[20:23], v[208:211]
    ds_read_b128 v[48:51], v132 offset:0
    v_mfma_f32_16x16x32_bf16 v[208:211], v[152:155], v[16:19], v[208:211]
    ds_read_b128 v[52:55], v133 offset:0
    v_mfma_f32_16x16x32_bf16 v[224:227], v[80:83], v[16:19], v[224:227]
    ds_read_b128 v[56:59], v132 offset:2048
    v_mfma_f32_16x16x32_bf16 v[224:227], v[84:87], v[20:23], v[224:227]
    ds_read_b128 v[60:63], v133 offset:2048
    v_mfma_f32_16x16x32_bf16 v[228:231], v[84:87], v[28:31], v[228:231]
    ds_read_b128 v[64:67], v132 offset:4096
    v_mfma_f32_16x16x32_bf16 v[228:231], v[80:83], v[24:27], v[228:231]
    ds_read_b128 v[68:71], v133 offset:4096
    v_mfma_f32_16x16x32_bf16 v[232:235], v[80:83], v[32:35], v[232:235]
    ds_read_b128 v[72:75], v132 offset:6144
    v_mfma_f32_16x16x32_bf16 v[232:235], v[84:87], v[36:39], v[232:235]
    ds_read_b128 v[76:79], v133 offset:6144
    v_mfma_f32_16x16x32_bf16 v[236:239], v[84:87], v[44:47], v[236:239]
    ds_read_b64_tr_b16 v[152:153], v134 offset:12288
    v_mfma_f32_16x16x32_bf16 v[236:239], v[80:83], v[40:43], v[236:239]
    ds_read_b64_tr_b16 v[154:155], v134 offset:13056
    v_mfma_f32_16x16x32_bf16 v[252:255], v[88:91], v[40:43], v[252:255]
    ds_read_b64_tr_b16 v[156:157], v134 offset:18432
    v_mfma_f32_16x16x32_bf16 v[252:255], v[92:95], v[44:47], v[252:255]
    ds_read_b64_tr_b16 v[158:159], v134 offset:19200
    v_mfma_f32_16x16x32_bf16 v[248:251], v[92:95], v[36:39], v[248:251]
    ds_read_b64_tr_b16 v[80:81], v135 offset:0
    v_mfma_f32_16x16x32_bf16 v[248:251], v[88:91], v[32:35], v[248:251]
    ds_read_b64_tr_b16 v[82:83], v135 offset:768
    v_mfma_f32_16x16x32_bf16 v[244:247], v[88:91], v[24:27], v[244:247]
    ds_read_b64_tr_b16 v[84:85], v135 offset:6144
    v_mfma_f32_16x16x32_bf16 v[244:247], v[92:95], v[28:31], v[244:247]
    ds_read_b64_tr_b16 v[86:87], v135 offset:6912
    v_mfma_f32_16x16x32_bf16 v[240:243], v[92:95], v[20:23], v[240:243]
    v_mfma_f32_16x16x32_bf16 v[240:243], v[88:91], v[16:19], v[240:243]
    ds_read_b64_tr_b16 v[88:89], v135 offset:12288
    s_waitcnt lgkmcnt(13)
    v_mfma_f32_16x16x32_bf16 v[160:163], v[96:99], v[48:51], v[160:163]
    ds_read_b64_tr_b16 v[90:91], v135 offset:13056
    v_mfma_f32_16x16x32_bf16 v[160:163], v[100:103], v[52:55], v[160:163]
    ds_read_b64_tr_b16 v[92:93], v135 offset:18432
    v_mfma_f32_16x16x32_bf16 v[164:167], v[100:103], v[60:63], v[164:167]
    ds_read_b64_tr_b16 v[94:95], v135 offset:19200
    v_mfma_f32_16x16x32_bf16 v[164:167], v[96:99], v[56:59], v[164:167]
    s_waitcnt lgkmcnt(12)
    v_mfma_f32_16x16x32_bf16 v[168:171], v[96:99], v[64:67], v[168:171]
    v_mfma_f32_16x16x32_bf16 v[168:171], v[100:103], v[68:71], v[168:171]
    v_mfma_f32_16x16x32_bf16 v[172:175], v[100:103], v[76:79], v[172:175]
    v_mfma_f32_16x16x32_bf16 v[172:175], v[96:99], v[72:75], v[172:175]
    ds_read_b64_tr_b16 v[96:97], v134 offset:64
    s_waitcnt lgkmcnt(9)
    v_mfma_f32_16x16x32_bf16 v[188:191], v[152:155], v[72:75], v[188:191]
    ds_read_b64_tr_b16 v[98:99], v134 offset:832
    v_mfma_f32_16x16x32_bf16 v[188:191], v[156:159], v[76:79], v[188:191]
    ds_read_b64_tr_b16 v[100:101], v134 offset:6208
    v_mfma_f32_16x16x32_bf16 v[184:187], v[156:159], v[68:71], v[184:187]
    ds_read_b64_tr_b16 v[102:103], v134 offset:6976
    v_mfma_f32_16x16x32_bf16 v[184:187], v[152:155], v[64:67], v[184:187]
    v_mfma_f32_16x16x32_bf16 v[180:183], v[152:155], v[56:59], v[180:183]
    v_mfma_f32_16x16x32_bf16 v[180:183], v[156:159], v[60:63], v[180:183]
    v_mfma_f32_16x16x32_bf16 v[176:179], v[156:159], v[52:55], v[176:179]
    v_mfma_f32_16x16x32_bf16 v[176:179], v[152:155], v[48:51], v[176:179]
    ds_read_b64_tr_b16 v[152:153], v134 offset:12352
    s_waitcnt lgkmcnt(9)
    v_mfma_f32_16x16x32_bf16 v[192:195], v[80:83], v[48:51], v[192:195]
    ds_read_b64_tr_b16 v[154:155], v134 offset:13120
    v_mfma_f32_16x16x32_bf16 v[192:195], v[84:87], v[52:55], v[192:195]
    ds_read_b64_tr_b16 v[156:157], v134 offset:18496
    v_mfma_f32_16x16x32_bf16 v[196:199], v[84:87], v[60:63], v[196:199]
    ds_read_b64_tr_b16 v[158:159], v134 offset:19264
    v_mfma_f32_16x16x32_bf16 v[196:199], v[80:83], v[56:59], v[196:199]
    v_mfma_f32_16x16x32_bf16 v[200:203], v[80:83], v[64:67], v[200:203]
    v_mfma_f32_16x16x32_bf16 v[200:203], v[84:87], v[68:71], v[200:203]
    v_mfma_f32_16x16x32_bf16 v[204:207], v[84:87], v[76:79], v[204:207]
    v_mfma_f32_16x16x32_bf16 v[204:207], v[80:83], v[72:75], v[204:207]
    s_waitcnt lgkmcnt(8)
    v_mfma_f32_16x16x32_bf16 v[220:223], v[88:91], v[72:75], v[220:223]
    v_mfma_f32_16x16x32_bf16 v[220:223], v[92:95], v[76:79], v[220:223]
    s_waitcnt lgkmcnt(0)
    s_barrier
    v_mfma_f32_16x16x32_bf16 v[216:219], v[92:95], v[68:71], v[216:219]
    ds_read_b64_tr_b16 v[80:81], v138 offset:0
    v_mfma_f32_16x16x32_bf16 v[216:219], v[88:91], v[64:67], v[216:219]
    ds_read_b64_tr_b16 v[82:83], v138 offset:768
    v_mfma_f32_16x16x32_bf16 v[212:215], v[88:91], v[56:59], v[212:215]
    ds_read_b64_tr_b16 v[84:85], v138 offset:6144
    v_mfma_f32_16x16x32_bf16 v[212:215], v[92:95], v[60:63], v[212:215]
    ds_read_b64_tr_b16 v[86:87], v138 offset:6912
    v_mfma_f32_16x16x32_bf16 v[208:211], v[92:95], v[52:55], v[208:211]
    ds_read_b128 v[16:19], v136 offset:0
    v_mfma_f32_16x16x32_bf16 v[208:211], v[88:91], v[48:51], v[208:211]
    ds_read_b128 v[20:23], v137 offset:0
    v_mfma_f32_16x16x32_bf16 v[224:227], v[96:99], v[48:51], v[224:227]
    ds_read_b128 v[24:27], v136 offset:2048
    v_mfma_f32_16x16x32_bf16 v[224:227], v[100:103], v[52:55], v[224:227]
    ds_read_b128 v[28:31], v137 offset:2048
    v_mfma_f32_16x16x32_bf16 v[228:231], v[100:103], v[60:63], v[228:231]
    ds_read_b128 v[32:35], v136 offset:4096
    v_mfma_f32_16x16x32_bf16 v[228:231], v[96:99], v[56:59], v[228:231]
    ds_read_b128 v[36:39], v137 offset:4096
    v_mfma_f32_16x16x32_bf16 v[232:235], v[96:99], v[64:67], v[232:235]
    ds_read_b128 v[40:43], v136 offset:6144
    v_mfma_f32_16x16x32_bf16 v[232:235], v[100:103], v[68:71], v[232:235]
    ds_read_b128 v[44:47], v137 offset:6144
    v_mfma_f32_16x16x32_bf16 v[236:239], v[100:103], v[76:79], v[236:239]
    ds_read_b64_tr_b16 v[88:89], v138 offset:12288
    v_mfma_f32_16x16x32_bf16 v[236:239], v[96:99], v[72:75], v[236:239]
    ds_read_b64_tr_b16 v[90:91], v138 offset:13056
    v_mfma_f32_16x16x32_bf16 v[252:255], v[152:155], v[72:75], v[252:255]
    ds_read_b64_tr_b16 v[92:93], v138 offset:18432
    v_mfma_f32_16x16x32_bf16 v[252:255], v[156:159], v[76:79], v[252:255]
    ds_read_b64_tr_b16 v[94:95], v138 offset:19200
    v_mfma_f32_16x16x32_bf16 v[248:251], v[156:159], v[68:71], v[248:251]
    ds_read_b64_tr_b16 v[96:97], v139 offset:0
    v_mfma_f32_16x16x32_bf16 v[248:251], v[152:155], v[64:67], v[248:251]
    ds_read_b64_tr_b16 v[98:99], v139 offset:768
    v_mfma_f32_16x16x32_bf16 v[244:247], v[152:155], v[56:59], v[244:247]
    ds_read_b64_tr_b16 v[100:101], v139 offset:6144
    v_mfma_f32_16x16x32_bf16 v[244:247], v[156:159], v[60:63], v[244:247]
    ds_read_b64_tr_b16 v[102:103], v139 offset:6912
    v_mfma_f32_16x16x32_bf16 v[240:243], v[156:159], v[52:55], v[240:243]
    v_mfma_f32_16x16x32_bf16 v[240:243], v[152:155], v[48:51], v[240:243]
    ds_read_b64_tr_b16 v[152:153], v139 offset:12288
    s_waitcnt lgkmcnt(13)
    v_mfma_f32_16x16x32_bf16 v[160:163], v[80:83], v[16:19], v[160:163]
    ds_read_b64_tr_b16 v[154:155], v139 offset:13056
    v_mfma_f32_16x16x32_bf16 v[160:163], v[84:87], v[20:23], v[160:163]
    ds_read_b64_tr_b16 v[156:157], v139 offset:18432
    v_mfma_f32_16x16x32_bf16 v[164:167], v[84:87], v[28:31], v[164:167]
    ds_read_b64_tr_b16 v[158:159], v139 offset:19200
    v_mfma_f32_16x16x32_bf16 v[164:167], v[80:83], v[24:27], v[164:167]
    s_waitcnt lgkmcnt(12)
    v_mfma_f32_16x16x32_bf16 v[168:171], v[80:83], v[32:35], v[168:171]
    v_mfma_f32_16x16x32_bf16 v[168:171], v[84:87], v[36:39], v[168:171]
    v_mfma_f32_16x16x32_bf16 v[172:175], v[84:87], v[44:47], v[172:175]
    v_mfma_f32_16x16x32_bf16 v[172:175], v[80:83], v[40:43], v[172:175]
    ds_read_b64_tr_b16 v[80:81], v138 offset:64
    s_waitcnt lgkmcnt(9)
    v_mfma_f32_16x16x32_bf16 v[188:191], v[88:91], v[40:43], v[188:191]
    ds_read_b64_tr_b16 v[82:83], v138 offset:832
    v_mfma_f32_16x16x32_bf16 v[188:191], v[92:95], v[44:47], v[188:191]
    ds_read_b64_tr_b16 v[84:85], v138 offset:6208
    v_mfma_f32_16x16x32_bf16 v[184:187], v[92:95], v[36:39], v[184:187]
    ds_read_b64_tr_b16 v[86:87], v138 offset:6976
    v_mfma_f32_16x16x32_bf16 v[184:187], v[88:91], v[32:35], v[184:187]
    v_mfma_f32_16x16x32_bf16 v[180:183], v[88:91], v[24:27], v[180:183]
    v_mfma_f32_16x16x32_bf16 v[180:183], v[92:95], v[28:31], v[180:183]
    v_mfma_f32_16x16x32_bf16 v[176:179], v[92:95], v[20:23], v[176:179]
    v_mfma_f32_16x16x32_bf16 v[176:179], v[88:91], v[16:19], v[176:179]
    ds_read_b64_tr_b16 v[88:89], v138 offset:12352
    s_waitcnt lgkmcnt(9)
    v_mfma_f32_16x16x32_bf16 v[192:195], v[96:99], v[16:19], v[192:195]
    ds_read_b64_tr_b16 v[90:91], v138 offset:13120
    v_mfma_f32_16x16x32_bf16 v[192:195], v[100:103], v[20:23], v[192:195]
    ds_read_b64_tr_b16 v[92:93], v138 offset:18496
    v_mfma_f32_16x16x32_bf16 v[196:199], v[100:103], v[28:31], v[196:199]
    ds_read_b64_tr_b16 v[94:95], v138 offset:19264
    v_mfma_f32_16x16x32_bf16 v[196:199], v[96:99], v[24:27], v[196:199]
    v_mfma_f32_16x16x32_bf16 v[200:203], v[96:99], v[32:35], v[200:203]
    v_mfma_f32_16x16x32_bf16 v[200:203], v[100:103], v[36:39], v[200:203]
    v_mfma_f32_16x16x32_bf16 v[204:207], v[100:103], v[44:47], v[204:207]
    v_mfma_f32_16x16x32_bf16 v[204:207], v[96:99], v[40:43], v[204:207]
    s_waitcnt lgkmcnt(8)
    v_mfma_f32_16x16x32_bf16 v[220:223], v[152:155], v[40:43], v[220:223]
    v_mfma_f32_16x16x32_bf16 v[220:223], v[156:159], v[44:47], v[220:223]
    s_waitcnt lgkmcnt(0)
    s_barrier
    v_mfma_f32_16x16x32_bf16 v[216:219], v[156:159], v[36:39], v[216:219]
    ds_read_b64_tr_b16 v[96:97], v142 offset:0
    v_mfma_f32_16x16x32_bf16 v[216:219], v[152:155], v[32:35], v[216:219]
    ds_read_b64_tr_b16 v[98:99], v142 offset:768
    v_mfma_f32_16x16x32_bf16 v[212:215], v[152:155], v[24:27], v[212:215]
    ds_read_b64_tr_b16 v[100:101], v142 offset:6144
    v_mfma_f32_16x16x32_bf16 v[212:215], v[156:159], v[28:31], v[212:215]
    ds_read_b64_tr_b16 v[102:103], v142 offset:6912
    v_mfma_f32_16x16x32_bf16 v[208:211], v[156:159], v[20:23], v[208:211]
    ds_read_b128 v[48:51], v140 offset:0
    v_mfma_f32_16x16x32_bf16 v[208:211], v[152:155], v[16:19], v[208:211]
    ds_read_b128 v[52:55], v141 offset:0
    v_mfma_f32_16x16x32_bf16 v[224:227], v[80:83], v[16:19], v[224:227]
    ds_read_b128 v[56:59], v140 offset:2048
    v_mfma_f32_16x16x32_bf16 v[224:227], v[84:87], v[20:23], v[224:227]
    ds_read_b128 v[60:63], v141 offset:2048
    v_mfma_f32_16x16x32_bf16 v[228:231], v[84:87], v[28:31], v[228:231]
    ds_read_b128 v[64:67], v140 offset:4096
    v_mfma_f32_16x16x32_bf16 v[228:231], v[80:83], v[24:27], v[228:231]
    ds_read_b128 v[68:71], v141 offset:4096
    v_mfma_f32_16x16x32_bf16 v[232:235], v[80:83], v[32:35], v[232:235]
    ds_read_b128 v[72:75], v140 offset:6144
    v_mfma_f32_16x16x32_bf16 v[232:235], v[84:87], v[36:39], v[232:235]
    ds_read_b128 v[76:79], v141 offset:6144
    v_mfma_f32_16x16x32_bf16 v[236:239], v[84:87], v[44:47], v[236:239]
    ds_read_b64_tr_b16 v[152:153], v142 offset:12288
    v_mfma_f32_16x16x32_bf16 v[236:239], v[80:83], v[40:43], v[236:239]
    ds_read_b64_tr_b16 v[154:155], v142 offset:13056
    v_mfma_f32_16x16x32_bf16 v[252:255], v[88:91], v[40:43], v[252:255]
    ds_read_b64_tr_b16 v[156:157], v142 offset:18432
    v_mfma_f32_16x16x32_bf16 v[252:255], v[92:95], v[44:47], v[252:255]
    ds_read_b64_tr_b16 v[158:159], v142 offset:19200
    v_mfma_f32_16x16x32_bf16 v[248:251], v[92:95], v[36:39], v[248:251]
    ds_read_b64_tr_b16 v[80:81], v143 offset:0
    v_mfma_f32_16x16x32_bf16 v[248:251], v[88:91], v[32:35], v[248:251]
    ds_read_b64_tr_b16 v[82:83], v143 offset:768
    v_mfma_f32_16x16x32_bf16 v[244:247], v[88:91], v[24:27], v[244:247]
    ds_read_b64_tr_b16 v[84:85], v143 offset:6144
    v_mfma_f32_16x16x32_bf16 v[244:247], v[92:95], v[28:31], v[244:247]
    ds_read_b64_tr_b16 v[86:87], v143 offset:6912
    v_mfma_f32_16x16x32_bf16 v[240:243], v[92:95], v[20:23], v[240:243]
    v_mfma_f32_16x16x32_bf16 v[240:243], v[88:91], v[16:19], v[240:243]
    ds_read_b64_tr_b16 v[88:89], v143 offset:12288
    s_waitcnt lgkmcnt(13)
    v_mfma_f32_16x16x32_bf16 v[160:163], v[96:99], v[48:51], v[160:163]
    ds_read_b64_tr_b16 v[90:91], v143 offset:13056
    v_mfma_f32_16x16x32_bf16 v[160:163], v[100:103], v[52:55], v[160:163]
    ds_read_b64_tr_b16 v[92:93], v143 offset:18432
    v_mfma_f32_16x16x32_bf16 v[164:167], v[100:103], v[60:63], v[164:167]
    ds_read_b64_tr_b16 v[94:95], v143 offset:19200
    v_mfma_f32_16x16x32_bf16 v[164:167], v[96:99], v[56:59], v[164:167]
    s_waitcnt lgkmcnt(12)
    v_mfma_f32_16x16x32_bf16 v[168:171], v[96:99], v[64:67], v[168:171]
    v_mfma_f32_16x16x32_bf16 v[168:171], v[100:103], v[68:71], v[168:171]
    v_mfma_f32_16x16x32_bf16 v[172:175], v[100:103], v[76:79], v[172:175]
    v_mfma_f32_16x16x32_bf16 v[172:175], v[96:99], v[72:75], v[172:175]
    ds_read_b64_tr_b16 v[96:97], v142 offset:64
    s_waitcnt lgkmcnt(9)
    v_mfma_f32_16x16x32_bf16 v[188:191], v[152:155], v[72:75], v[188:191]
    ds_read_b64_tr_b16 v[98:99], v142 offset:832
    v_mfma_f32_16x16x32_bf16 v[188:191], v[156:159], v[76:79], v[188:191]
    ds_read_b64_tr_b16 v[100:101], v142 offset:6208
    v_mfma_f32_16x16x32_bf16 v[184:187], v[156:159], v[68:71], v[184:187]
    ds_read_b64_tr_b16 v[102:103], v142 offset:6976
    v_mfma_f32_16x16x32_bf16 v[184:187], v[152:155], v[64:67], v[184:187]
    v_mfma_f32_16x16x32_bf16 v[180:183], v[152:155], v[56:59], v[180:183]
    v_mfma_f32_16x16x32_bf16 v[180:183], v[156:159], v[60:63], v[180:183]
    v_mfma_f32_16x16x32_bf16 v[176:179], v[156:159], v[52:55], v[176:179]
    v_mfma_f32_16x16x32_bf16 v[176:179], v[152:155], v[48:51], v[176:179]
    ds_read_b64_tr_b16 v[152:153], v142 offset:12352
    s_waitcnt lgkmcnt(9)
    v_mfma_f32_16x16x32_bf16 v[192:195], v[80:83], v[48:51], v[192:195]
    ds_read_b64_tr_b16 v[154:155], v142 offset:13120
    v_mfma_f32_16x16x32_bf16 v[192:195], v[84:87], v[52:55], v[192:195]
    ds_read_b64_tr_b16 v[156:157], v142 offset:18496
    v_mfma_f32_16x16x32_bf16 v[196:199], v[84:87], v[60:63], v[196:199]
    ds_read_b64_tr_b16 v[158:159], v142 offset:19264
    v_mfma_f32_16x16x32_bf16 v[196:199], v[80:83], v[56:59], v[196:199]
    v_mfma_f32_16x16x32_bf16 v[200:203], v[80:83], v[64:67], v[200:203]
    v_mfma_f32_16x16x32_bf16 v[200:203], v[84:87], v[68:71], v[200:203]
    v_mfma_f32_16x16x32_bf16 v[204:207], v[84:87], v[76:79], v[204:207]
    v_mfma_f32_16x16x32_bf16 v[204:207], v[80:83], v[72:75], v[204:207]
    s_waitcnt lgkmcnt(8)
    v_mfma_f32_16x16x32_bf16 v[220:223], v[88:91], v[72:75], v[220:223]
    v_mfma_f32_16x16x32_bf16 v[220:223], v[92:95], v[76:79], v[220:223]
    s_waitcnt lgkmcnt(0)
    s_barrier
    v_mfma_f32_16x16x32_bf16 v[216:219], v[92:95], v[68:71], v[216:219]
    ds_read_b64_tr_b16 v[80:81], v134 offset:0
    v_mfma_f32_16x16x32_bf16 v[216:219], v[88:91], v[64:67], v[216:219]
    ds_read_b64_tr_b16 v[82:83], v134 offset:768
    v_mfma_f32_16x16x32_bf16 v[212:215], v[88:91], v[56:59], v[212:215]
    ds_read_b64_tr_b16 v[84:85], v134 offset:6144
    v_mfma_f32_16x16x32_bf16 v[212:215], v[92:95], v[60:63], v[212:215]
    ds_read_b64_tr_b16 v[86:87], v134 offset:6912
    v_mfma_f32_16x16x32_bf16 v[208:211], v[92:95], v[52:55], v[208:211]
    ds_read_b128 v[16:19], v132 offset:0
    v_mfma_f32_16x16x32_bf16 v[208:211], v[88:91], v[48:51], v[208:211]
    ds_read_b128 v[20:23], v133 offset:0
    v_mfma_f32_16x16x32_bf16 v[224:227], v[96:99], v[48:51], v[224:227]
    ds_read_b128 v[24:27], v132 offset:2048
    v_mfma_f32_16x16x32_bf16 v[224:227], v[100:103], v[52:55], v[224:227]
    ds_read_b128 v[28:31], v133 offset:2048
    v_mfma_f32_16x16x32_bf16 v[228:231], v[100:103], v[60:63], v[228:231]
    ds_read_b128 v[32:35], v132 offset:4096
    v_mfma_f32_16x16x32_bf16 v[228:231], v[96:99], v[56:59], v[228:231]
    ds_read_b128 v[36:39], v133 offset:4096
    v_mfma_f32_16x16x32_bf16 v[232:235], v[96:99], v[64:67], v[232:235]
    ds_read_b128 v[40:43], v132 offset:6144
    v_mfma_f32_16x16x32_bf16 v[232:235], v[100:103], v[68:71], v[232:235]
    ds_read_b128 v[44:47], v133 offset:6144
    v_mfma_f32_16x16x32_bf16 v[236:239], v[100:103], v[76:79], v[236:239]
    ds_read_b64_tr_b16 v[88:89], v134 offset:12288
    v_mfma_f32_16x16x32_bf16 v[236:239], v[96:99], v[72:75], v[236:239]
    ds_read_b64_tr_b16 v[90:91], v134 offset:13056
    v_mfma_f32_16x16x32_bf16 v[252:255], v[152:155], v[72:75], v[252:255]
    ds_read_b64_tr_b16 v[92:93], v134 offset:18432
    v_mfma_f32_16x16x32_bf16 v[252:255], v[156:159], v[76:79], v[252:255]
    ds_read_b64_tr_b16 v[94:95], v134 offset:19200
    v_mfma_f32_16x16x32_bf16 v[248:251], v[156:159], v[68:71], v[248:251]
    ds_read_b64_tr_b16 v[96:97], v135 offset:0
    v_mfma_f32_16x16x32_bf16 v[248:251], v[152:155], v[64:67], v[248:251]
    ds_read_b64_tr_b16 v[98:99], v135 offset:768
    v_mfma_f32_16x16x32_bf16 v[244:247], v[152:155], v[56:59], v[244:247]
    ds_read_b64_tr_b16 v[100:101], v135 offset:6144
    v_mfma_f32_16x16x32_bf16 v[244:247], v[156:159], v[60:63], v[244:247]
    ds_read_b64_tr_b16 v[102:103], v135 offset:6912
    v_mfma_f32_16x16x32_bf16 v[240:243], v[156:159], v[52:55], v[240:243]
    v_mfma_f32_16x16x32_bf16 v[240:243], v[152:155], v[48:51], v[240:243]
    ds_read_b64_tr_b16 v[152:153], v135 offset:12288
    s_waitcnt lgkmcnt(13)
    v_mfma_f32_16x16x32_bf16 v[160:163], v[80:83], v[16:19], v[160:163]
    ds_read_b64_tr_b16 v[154:155], v135 offset:13056
    v_mfma_f32_16x16x32_bf16 v[160:163], v[84:87], v[20:23], v[160:163]
    ds_read_b64_tr_b16 v[156:157], v135 offset:18432
    v_mfma_f32_16x16x32_bf16 v[164:167], v[84:87], v[28:31], v[164:167]
    ds_read_b64_tr_b16 v[158:159], v135 offset:19200
    v_mfma_f32_16x16x32_bf16 v[164:167], v[80:83], v[24:27], v[164:167]
    s_waitcnt lgkmcnt(12)
    v_mfma_f32_16x16x32_bf16 v[168:171], v[80:83], v[32:35], v[168:171]
    v_mfma_f32_16x16x32_bf16 v[168:171], v[84:87], v[36:39], v[168:171]
    v_mfma_f32_16x16x32_bf16 v[172:175], v[84:87], v[44:47], v[172:175]
    v_mfma_f32_16x16x32_bf16 v[172:175], v[80:83], v[40:43], v[172:175]
    ds_read_b64_tr_b16 v[80:81], v134 offset:64
    s_waitcnt lgkmcnt(9)
    v_mfma_f32_16x16x32_bf16 v[188:191], v[88:91], v[40:43], v[188:191]
    ds_read_b64_tr_b16 v[82:83], v134 offset:832
    v_mfma_f32_16x16x32_bf16 v[188:191], v[92:95], v[44:47], v[188:191]
    ds_read_b64_tr_b16 v[84:85], v134 offset:6208
    v_mfma_f32_16x16x32_bf16 v[184:187], v[92:95], v[36:39], v[184:187]
    ds_read_b64_tr_b16 v[86:87], v134 offset:6976
    v_mfma_f32_16x16x32_bf16 v[184:187], v[88:91], v[32:35], v[184:187]
    v_mfma_f32_16x16x32_bf16 v[180:183], v[88:91], v[24:27], v[180:183]
    v_mfma_f32_16x16x32_bf16 v[180:183], v[92:95], v[28:31], v[180:183]
    v_mfma_f32_16x16x32_bf16 v[176:179], v[92:95], v[20:23], v[176:179]
    v_mfma_f32_16x16x32_bf16 v[176:179], v[88:91], v[16:19], v[176:179]
    ds_read_b64_tr_b16 v[88:89], v134 offset:12352
    s_waitcnt lgkmcnt(9)
    v_mfma_f32_16x16x32_bf16 v[192:195], v[96:99], v[16:19], v[192:195]
    ds_read_b64_tr_b16 v[90:91], v134 offset:13120
    v_mfma_f32_16x16x32_bf16 v[192:195], v[100:103], v[20:23], v[192:195]
    ds_read_b64_tr_b16 v[92:93], v134 offset:18496
    v_mfma_f32_16x16x32_bf16 v[196:199], v[100:103], v[28:31], v[196:199]
    ds_read_b64_tr_b16 v[94:95], v134 offset:19264
    v_mfma_f32_16x16x32_bf16 v[196:199], v[96:99], v[24:27], v[196:199]
    v_mfma_f32_16x16x32_bf16 v[200:203], v[96:99], v[32:35], v[200:203]
    ds_read_b32 v3, v15 offset:160
    v_mfma_f32_16x16x32_bf16 v[200:203], v[100:103], v[36:39], v[200:203]
    v_mfma_f32_16x16x32_bf16 v[204:207], v[100:103], v[44:47], v[204:207]
    v_mfma_f32_16x16x32_bf16 v[204:207], v[96:99], v[40:43], v[204:207]
    s_waitcnt lgkmcnt(9)
    v_mfma_f32_16x16x32_bf16 v[220:223], v[152:155], v[40:43], v[220:223]
    s_waitcnt lgkmcnt(0)
    v_cmp_eq_u32 vcc, 0, v3
    v_mfma_f32_16x16x32_bf16 v[220:223], v[156:159], v[44:47], v[220:223]
    s_cbranch_vccnz L_slow_c7
L_back_c7:
    v_mfma_f32_16x16x32_bf16 v[216:219], v[156:159], v[36:39], v[216:219]
    ds_read_b64_tr_b16 v[96:97], v138 offset:0
    v_mfma_f32_16x16x32_bf16 v[216:219], v[152:155], v[32:35], v[216:219]
    ds_read_b64_tr_b16 v[98:99], v138 offset:768
    v_mfma_f32_16x16x32_bf16 v[212:215], v[152:155], v[24:27], v[212:215]
    ds_read_b64_tr_b16 v[100:101], v138 offset:6144
    v_mfma_f32_16x16x32_bf16 v[212:215], v[156:159], v[28:31], v[212:215]
    ds_read_b64_tr_b16 v[102:103], v138 offset:6912
    v_mfma_f32_16x16x32_bf16 v[208:211], v[156:159], v[20:23], v[208:211]
    ds_read_b128 v[48:51], v136 offset:0
    v_mfma_f32_16x16x32_bf16 v[208:211], v[152:155], v[16:19], v[208:211]
    ds_read_b128 v[52:55], v137 offset:0
    v_mfma_f32_16x16x32_bf16 v[224:227], v[80:83], v[16:19], v[224:227]
    ds_read_b128 v[56:59], v136 offset:2048
    v_mfma_f32_16x16x32_bf16 v[224:227], v[84:87], v[20:23], v[224:227]
    ds_read_b128 v[60:63], v137 offset:2048
    v_mfma_f32_16x16x32_bf16 v[228:231], v[84:87], v[28:31], v[228:231]
    ds_read_b128 v[64:67], v136 offset:4096
    v_mfma_f32_16x16x32_bf16 v[228:231], v[80:83], v[24:27], v[228:231]
    ds_read_b128 v[68:71], v137 offset:4096
    v_mfma_f32_16x16x32_bf16 v[232:235], v[80:83], v[32:35], v[232:235]
    ds_read_b128 v[72:75], v136 offset:6144
    v_mfma_f32_16x16x32_bf16 v[232:235], v[84:87], v[36:39], v[232:235]
    ds_read_b128 v[76:79], v137 offset:6144
    v_mfma_f32_16x16x32_bf16 v[236:239], v[84:87], v[44:47], v[236:239]
    ds_read_b64_tr_b16 v[152:153], v138 offset:12288
    v_mfma_f32_16x16x32_bf16 v[236:239], v[80:83], v[40:43], v[236:239]
    ds_read_b64_tr_b16 v[154:155], v138 offset:13056
    v_mfma_f32_16x16x32_bf16 v[252:255], v[88:91], v[40:43], v[252:255]
    ds_read_b64_tr_b16 v[156:157], v138 offset:18432
    v_mfma_f32_16x16x32_bf16 v[252:255], v[92:95], v[44:47], v[252:255]
    ds_read_b64_tr_b16 v[158:159], v138 offset:19200
    v_mfma_f32_16x16x32_bf16 v[248:251], v[92:95], v[36:39], v[248:251]
    ds_read_b64_tr_b16 v[80:81], v139 offset:0
    v_mfma_f32_16x16x32_bf16 v[248:251], v[88:91], v[32:35], v[248:251]
    ds_read_b64_tr_b16 v[82:83], v139 offset:768
    v_mfma_f32_16x16x32_bf16 v[244:247], v[88:91], v[24:27], v[244:247]
    ds_read_b64_tr_b16 v[84:85], v139 offset:6144
    v_mfma_f32_16x16x32_bf16 v[244:247], v[92:95], v[28:31], v[244:247]
    ds_read_b64_tr_b16 v[86:87], v139 offset:6912
    v_mfma_f32_16x16x32_bf16 v[240:243], v[92:95], v[20:23], v[240:243]
    v_mfma_f32_16x16x32_bf16 v[240:243], v[88:91], v[16:19], v[240:243]
    ds_read_b64_tr_b16 v[88:89], v139 offset:12288
    s_waitcnt lgkmcnt(13)
    v_mfma_f32_16x16x32_bf16 v[160:163], v[96:99], v[48:51], v[160:163]
    ds_read_b64_tr_b16 v[90:91], v139 offset:13056
    v_mfma_f32_16x16x32_bf16 v[160:163], v[100:103], v[52:55], v[160:163]
    ds_read_b64_tr_b16 v[92:93], v139 offset:18432
    v_mfma_f32_16x16x32_bf16 v[164:167], v[100:103], v[60:63], v[164:167]
    ds_read_b64_tr_b16 v[94:95], v139 offset:19200
    v_mfma_f32_16x16x32_bf16 v[164:167], v[96:99], v[56:59], v[164:167]
    s_waitcnt lgkmcnt(12)
    v_mfma_f32_16x16x32_bf16 v[168:171], v[96:99], v[64:67], v[168:171]
    v_mfma_f32_16x16x32_bf16 v[168:171], v[100:103], v[68:71], v[168:171]
    v_mfma_f32_16x16x32_bf16 v[172:175], v[100:103], v[76:79], v[172:175]
    v_mfma_f32_16x16x32_bf16 v[172:175], v[96:99], v[72:75], v[172:175]
    ds_read_b64_tr_b16 v[96:97], v138 offset:64
    s_waitcnt lgkmcnt(9)
    v_mfma_f32_16x16x32_bf16 v[188:191], v[152:155], v[72:75], v[188:191]
    ds_read_b64_tr_b16 v[98:99], v138 offset:832
    v_mfma_f32_16x16x32_bf16 v[188:191], v[156:159], v[76:79], v[188:191]
    ds_read_b64_tr_b16 v[100:101], v138 offset:6208
    v_mfma_f32_16x16x32_bf16 v[184:187], v[156:159], v[68:71], v[184:187]
    ds_read_b64_tr_b16 v[102:103], v138 offset:6976
    v_mfma_f32_16x16x32_bf16 v[184:187], v[152:155], v[64:67], v[184:187]
    v_mfma_f32_16x16x32_bf16 v[180:183], v[152:155], v[56:59], v[180:183]
    v_mfma_f32_16x16x32_bf16 v[180:183], v[156:159], v[60:63], v[180:183]
    v_mfma_f32_16x16x32_bf16 v[176:179], v[156:159], v[52:55], v[176:179]
    v_mfma_f32_16x16x32_bf16 v[176:179], v[152:155], v[48:51], v[176:179]
    ds_read_b64_tr_b16 v[152:153], v138 offset:12352
    s_waitcnt lgkmcnt(9)
    v_mfma_f32_16x16x32_bf16 v[192:195], v[80:83], v[48:51], v[192:195]
    ds_read_b64_tr_b16 v[154:155], v138 offset:13120
    v_mfma_f32_16x16x32_bf16 v[192:195], v[84:87], v[52:55], v[192:195]
    ds_read_b64_tr_b16 v[156:157], v138 offset:18496
    v_mfma_f32_16x16x32_bf16 v[196:199], v[84:87], v[60:63], v[196:199]
    ds_read_b64_tr_b16 v[158:159], v138 offset:19264
    v_mfma_f32_16x16x32_bf16 v[196:199], v[80:83], v[56:59], v[196:199]
    v_mfma_f32_16x16x32_bf16 v[200:203], v[80:83], v[64:67], v[200:203]
    v_mfma_f32_16x16x32_bf16 v[200:203], v[84:87], v[68:71], v[200:203]
    v_mfma_f32_16x16x32_bf16 v[204:207], v[84:87], v[76:79], v[204:207]
    v_mfma_f32_16x16x32_bf16 v[204:207], v[80:83], v[72:75], v[204:207]
    s_waitcnt lgkmcnt(8)
    v_mfma_f32_16x16x32_bf16 v[220:223], v[88:91], v[72:75], v[220:223]
    v_mfma_f32_16x16x32_bf16 v[220:223], v[92:95], v[76:79], v[220:223]
    v_mfma_f32_16x16x32_bf16 v[216:219], v[92:95], v[68:71], v[216:219]
    v_mfma_f32_16x16x32_bf16 v[216:219], v[88:91], v[64:67], v[216:219]
    v_mfma_f32_16x16x32_bf16 v[212:215], v[88:91], v[56:59], v[212:215]
    v_mfma_f32_16x16x32_bf16 v[212:215], v[92:95], v[60:63], v[212:215]
    v_mfma_f32_16x16x32_bf16 v[208:211], v[92:95], v[52:55], v[208:211]
    ds_read_b32 v3, v15 offset:176
    v_mfma_f32_16x16x32_bf16 v[208:211], v[88:91], v[48:51], v[208:211]
    s_waitcnt lgkmcnt(5)
    v_mfma_f32_16x16x32_bf16 v[224:227], v[96:99], v[48:51], v[224:227]
    v_mfma_f32_16x16x32_bf16 v[224:227], v[100:103], v[52:55], v[224:227]
    v_mfma_f32_16x16x32_bf16 v[228:231], v[100:103], v[60:63], v[228:231]
    s_waitcnt lgkmcnt(0)
    v_cmp_eq_u32 vcc, 0, v3
    v_mfma_f32_16x16x32_bf16 v[228:231], v[96:99], v[56:59], v[228:231]
    s_cbranch_vccnz L_slow_cs
L_back_cs:
    v_mfma_f32_16x16x32_bf16 v[232:235], v[96:99], v[64:67], v[232:235]
    ds_read2_b32 v[128:129], v145 offset0:0 offset1:16
    v_mfma_f32_16x16x32_bf16 v[232:235], v[100:103], v[68:71], v[232:235]
    ds_read2_b32 v[130:131], v145 offset0:32 offset1:48
    v_mfma_f32_16x16x32_bf16 v[236:239], v[100:103], v[76:79], v[236:239]
    ds_read_b128 v[104:107], v144 offset:0
    v_mfma_f32_16x16x32_bf16 v[236:239], v[96:99], v[72:75], v[236:239]
    ds_read_b128 v[108:111], v144 offset:384
    v_mfma_f32_16x16x32_bf16 v[252:255], v[152:155], v[72:75], v[252:255]
    ds_read_b128 v[112:115], v144 offset:64
    v_mfma_f32_16x16x32_bf16 v[252:255], v[156:159], v[76:79], v[252:255]
    ds_read_b128 v[116:119], v144 offset:448
    v_mfma_f32_16x16x32_bf16 v[248:251], v[156:159], v[68:71], v[248:251]
    ds_read_b128 v[120:123], v144 offset:128
    v_mfma_f32_16x16x32_bf16 v[248:251], v[152:155], v[64:67], v[248:251]
    ds_read_b128 v[124:127], v144 offset:512
    v_mfma_f32_16x16x32_bf16 v[244:247], v[152:155], v[56:59], v[244:247]
    ds_write_b32 v14, v13 offset:0
    v_mfma_f32_16x16x32_bf16 v[244:247], v[156:159], v[60:63], v[244:247]
    v_mfma_f32_16x16x32_bf16 v[240:243], v[156:159], v[52:55], v[240:243]
    v_mfma_f32_16x16x32_bf16 v[240:243], v[152:155], v[48:51], v[240:243]
    s_setprio 3
    s_waitcnt lgkmcnt(5)
    v_pk_fma_f32 v[160:161], v[128:129], v[104:105], v[160:161] op_sel:[0,0,0] op_sel_hi:[0,1,1] neg_lo:[1,0,0] neg_hi:[1,0,0]
    v_pk_fma_f32 v[162:163], v[128:129], v[106:107], v[162:163] op_sel:[0,0,0] op_sel_hi:[0,1,1] neg_lo:[1,0,0] neg_hi:[1,0,0]
    v_pk_fma_f32 v[164:165], v[128:129], v[104:105], v[164:165] op_sel:[1,0,0] op_sel_hi:[1,1,1] neg_lo:[1,0,0] neg_hi:[1,0,0]
    v_pk_fma_f32 v[166:167], v[128:129], v[106:107], v[166:167] op_sel:[1,0,0] op_sel_hi:[1,1,1] neg_lo:[1,0,0] neg_hi:[1,0,0]
    v_pk_fma_f32 v[168:169], v[130:131], v[104:105], v[168:169] op_sel:[0,0,0] op_sel_hi:[0,1,1] neg_lo:[1,0,0] neg_hi:[1,0,0]
    v_pk_fma_f32 v[170:171], v[130:131], v[106:107], v[170:171] op_sel:[0,0,0] op_sel_hi:[0,1,1] neg_lo:[1,0,0] neg_hi:[1,0,0]
    v_pk_fma_f32 v[172:173], v[130:131], v[104:105], v[172:173] op_sel:[1,0,0] op_sel_hi:[1,1,1] neg_lo:[1,0,0] neg_hi:[1,0,0]
    v_pk_fma_f32 v[174:175], v[130:131], v[106:107], v[174:175] op_sel:[1,0,0] op_sel_hi:[1,1,1] neg_lo:[1,0,0] neg_hi:[1,0,0]
    v_pk_fma_f32 v[176:177], v[128:129], v[108:109], v[176:177] op_sel:[0,0,0] op_sel_hi:[0,1,1] neg_lo:[1,0,0] neg_hi:[1,0,0]
    v_pk_fma_f32 v[178:179], v[128:129], v[110:111], v[178:179] op_sel:[0,0,0] op_sel_hi:[0,1,1] neg_lo:[1,0,0] neg_hi:[1,0,0]
    v_pk_fma_f32 v[180:181], v[128:129], v[108:109], v[180:181] op_sel:[1,0,0] op_sel_hi:[1,1,1] neg_lo:[1,0,0] neg_hi:[1,0,0]
    v_pk_fma_f32 v[182:183], v[128:129], v[110:111], v[182:183] op_sel:[1,0,0] op_sel_hi:[1,1,1] neg_lo:[1,0,0] neg_hi:[1,0,0]
    v_pk_fma_f32 v[184:185], v[130:131], v[108:109], v[184:185] op_sel:[0,0,0] op_sel_hi:[0,1,1] neg_lo:[1,0,0] neg_hi:[1,0,0]
    v_pk_fma_f32 v[186:187], v[130:131], v[110:111], v[186:187] op_sel:[0,0,0] op_sel_hi:[0,1,1] neg_lo:[1,0,0] neg_hi:[1,0,0]
    v_pk_fma_f32 v[188:189], v[130:131], v[108:109], v[188:189] op_sel:[1,0,0] op_sel_hi:[1,1,1] neg_lo:[1,0,0] neg_hi:[1,0,0]
    v_pk_fma_f32 v[190:191], v[130:131], v[110:111], v[190:191] op_sel:[1,0,0] op_sel_hi:[1,1,1] neg_lo:[1,0,0] neg_hi:[1,0,0]
    v_pk_mul_f32 v[160:161], v[160:161], v[176:177]
    v_pk_mul_f32 v[162:163], v[162:163], v[178:179]
    v_pk_mul_f32 v[164:165], v[164:165], v[180:181]
    v_pk_mul_f32 v[166:167], v[166:167], v[182:183]
    v_pk_mul_f32 v[168:169], v[168:169], v[184:185]
    v_pk_mul_f32 v[170:171], v[170:171], v[186:187]
    v_pk_mul_f32 v[172:173], v[172:173], v[188:189]
    v_pk_mul_f32 v[174:175], v[174:175], v[190:191]
    s_waitcnt lgkmcnt(3)
    v_pk_fma_f32 v[192:193], v[128:129], v[112:113], v[192:193] op_sel:[0,0,0] op_sel_hi:[0,1,1] neg_lo:[1,0,0] neg_hi:[1,0,0]
    v_pk_fma_f32 v[194:195], v[128:129], v[114:115], v[194:195] op_sel:[0,0,0] op_sel_hi:[0,1,1] neg_lo:[1,0,0] neg_hi:[1,0,0]
    v_pk_fma_f32 v[196:197], v[128:129], v[112:113], v[196:197] op_sel:[1,0,0] op_sel_hi:[1,1,1] neg_lo:[1,0,0] neg_hi:[1,0,0]
    v_pk_fma_f32 v[198:199], v[128:129], v[114:115], v[198:199] op_sel:[1,0,0] op_sel_hi:[1,1,1] neg_lo:[1,0,0] neg_hi:[1,0,0]
    v_pk_fma_f32 v[200:201], v[130:131], v[112:113], v[200:201] op_sel:[0,0,0] op_sel_hi:[0,1,1] neg_lo:[1,0,0] neg_hi:[1,0,0]
    v_pk_fma_f32 v[202:203], v[130:131], v[114:115], v[202:203] op_sel:[0,0,0] op_sel_hi:[0,1,1] neg_lo:[1,0,0] neg_hi:[1,0,0]
    v_pk_fma_f32 v[204:205], v[130:131], v[112:113], v[204:205] op_sel:[1,0,0] op_sel_hi:[1,1,1] neg_lo:[1,0,0] neg_hi:[1,0,0]
    v_pk_fma_f32 v[206:207], v[130:131], v[114:115], v[206:207] op_sel:[1,0,0] op_sel_hi:[1,1,1] neg_lo:[1,0,0] neg_hi:[1,0,0]
    v_pk_fma_f32 v[208:209], v[128:129], v[116:117], v[208:209] op_sel:[0,0,0] op_sel_hi:[0,1,1] neg_lo:[1,0,0] neg_hi:[1,0,0]
    v_pk_fma_f32 v[210:211], v[128:129], v[118:119], v[210:211] op_sel:[0,0,0] op_sel_hi:[0,1,1] neg_lo:[1,0,0] neg_hi:[1,0,0]
    v_pk_fma_f32 v[212:213], v[128:129], v[116:117], v[212:213] op_sel:[1,0,0] op_sel_hi:[1,1,1] neg_lo:[1,0,0] neg_hi:[1,0,0]
    v_pk_fma_f32 v[214:215], v[128:129], v[118:119], v[214:215] op_sel:[1,0,0] op_sel_hi:[1,1,1] neg_lo:[1,0,0] neg_hi:[1,0,0]
    v_pk_fma_f32 v[216:217], v[130:131], v[116:117], v[216:217] op_sel:[0,0,0] op_sel_hi:[0,1,1] neg_lo:[1,0,0] neg_hi:[1,0,0]
    v_pk_fma_f32 v[218:219], v[130:131], v[118:119], v[218:219] op_sel:[0,0,0] op_sel_hi:[0,1,1] neg_lo:[1,0,0] neg_hi:[1,0,0]
    v_pk_fma_f32 v[220:221], v[130:131], v[116:117], v[220:221] op_sel:[1,0,0] op_sel_hi:[1,1,1] neg_lo:[1,0,0] neg_hi:[1,0,0]
    v_pk_fma_f32 v[222:223], v[130:131], v[118:119], v[222:223] op_sel:[1,0,0] op_sel_hi:[1,1,1] neg_lo:[1,0,0] neg_hi:[1,0,0]
    v_pk_mul_f32 v[192:193], v[192:193], v[208:209]
    v_pk_mul_f32 v[194:195], v[194:195], v[210:211]
    v_pk_mul_f32 v[196:197], v[196:197], v[212:213]
    v_pk_mul_f32 v[198:199], v[198:199], v[214:215]
    v_pk_mul_f32 v[200:201], v[200:201], v[216:217]
    v_pk_mul_f32 v[202:203], v[202:203], v[218:219]
    v_pk_mul_f32 v[204:205], v[204:205], v[220:221]
    v_pk_mul_f32 v[206:207], v[206:207], v[222:223]
    s_waitcnt lgkmcnt(1)
    v_pk_fma_f32 v[224:225], v[128:129], v[120:121], v[224:225] op_sel:[0,0,0] op_sel_hi:[0,1,1] neg_lo:[1,0,0] neg_hi:[1,0,0]
    v_pk_fma_f32 v[226:227], v[128:129], v[122:123], v[226:227] op_sel:[0,0,0] op_sel_hi:[0,1,1] neg_lo:[1,0,0] neg_hi:[1,0,0]
    v_pk_fma_f32 v[228:229], v[128:129], v[120:121], v[228:229] op_sel:[1,0,0] op_sel_hi:[1,1,1] neg_lo:[1,0,0] neg_hi:[1,0,0]
    v_pk_fma_f32 v[230:231], v[128:129], v[122:123], v[230:231] op_sel:[1,0,0] op_sel_hi:[1,1,1] neg_lo:[1,0,0] neg_hi:[1,0,0]
    v_pk_fma_f32 v[232:233], v[130:131], v[120:121], v[232:233] op_sel:[0,0,0] op_sel_hi:[0,1,1] neg_lo:[1,0,0] neg_hi:[1,0,0]
    v_pk_fma_f32 v[234:235], v[130:131], v[122:123], v[234:235] op_sel:[0,0,0] op_sel_hi:[0,1,1] neg_lo:[1,0,0] neg_hi:[1,0,0]
    v_pk_fma_f32 v[236:237], v[130:131], v[120:121], v[236:237] op_sel:[1,0,0] op_sel_hi:[1,1,1] neg_lo:[1,0,0] neg_hi:[1,0,0]
    v_pk_fma_f32 v[238:239], v[130:131], v[122:123], v[238:239] op_sel:[1,0,0] op_sel_hi:[1,1,1] neg_lo:[1,0,0] neg_hi:[1,0,0]
    v_pk_fma_f32 v[240:241], v[128:129], v[124:125], v[240:241] op_sel:[0,0,0] op_sel_hi:[0,1,1] neg_lo:[1,0,0] neg_hi:[1,0,0]
    v_pk_fma_f32 v[242:243], v[128:129], v[126:127], v[242:243] op_sel:[0,0,0] op_sel_hi:[0,1,1] neg_lo:[1,0,0] neg_hi:[1,0,0]
    v_pk_fma_f32 v[244:245], v[128:129], v[124:125], v[244:245] op_sel:[1,0,0] op_sel_hi:[1,1,1] neg_lo:[1,0,0] neg_hi:[1,0,0]
    v_pk_fma_f32 v[246:247], v[128:129], v[126:127], v[246:247] op_sel:[1,0,0] op_sel_hi:[1,1,1] neg_lo:[1,0,0] neg_hi:[1,0,0]
    v_pk_fma_f32 v[248:249], v[130:131], v[124:125], v[248:249] op_sel:[0,0,0] op_sel_hi:[0,1,1] neg_lo:[1,0,0] neg_hi:[1,0,0]
    v_pk_fma_f32 v[250:251], v[130:131], v[126:127], v[250:251] op_sel:[0,0,0] op_sel_hi:[0,1,1] neg_lo:[1,0,0] neg_hi:[1,0,0]
    v_pk_fma_f32 v[252:253], v[130:131], v[124:125], v[252:253] op_sel:[1,0,0] op_sel_hi:[1,1,1] neg_lo:[1,0,0] neg_hi:[1,0,0]
    v_pk_fma_f32 v[254:255], v[130:131], v[126:127], v[254:255] op_sel:[1,0,0] op_sel_hi:[1,1,1] neg_lo:[1,0,0] neg_hi:[1,0,0]
    v_pk_mul_f32 v[224:225], v[224:225], v[240:241]
    v_pk_mul_f32 v[226:227], v[226:227], v[242:243]
    v_pk_mul_f32 v[228:229], v[228:229], v[244:245]
    v_pk_mul_f32 v[230:231], v[230:231], v[246:247]
    v_pk_mul_f32 v[232:233], v[232:233], v[248:249]
    v_pk_mul_f32 v[234:235], v[234:235], v[250:251]
    v_pk_mul_f32 v[236:237], v[236:237], v[252:253]
    v_pk_mul_f32 v[238:239], v[238:239], v[254:255]
    ds_write_b32 v14, v13 offset:128
    v_cvt_pk_bf16_f32 v176, v160, v161
    v_cvt_pk_bf16_f32 v177, v162, v163
    v_cvt_pk_bf16_f32 v178, v164, v165
    v_cvt_pk_bf16_f32 v179, v166, v167
    v_cvt_pk_bf16_f32 v184, v168, v169
    v_cvt_pk_bf16_f32 v185, v170, v171
    v_cvt_pk_bf16_f32 v186, v172, v173
    v_cvt_pk_bf16_f32 v187, v174, v175
    v_permlane16_swap_b32 v176, v178
    v_permlane16_swap_b32 v177, v179
    v_permlane16_swap_b32 v184, v186
    v_permlane16_swap_b32 v185, v187
    v_cvt_pk_bf16_f32 v208, v192, v193
    v_cvt_pk_bf16_f32 v209, v194, v195
    v_cvt_pk_bf16_f32 v210, v196, v197
    v_cvt_pk_bf16_f32 v211, v198, v199
    v_cvt_pk_bf16_f32 v216, v200, v201
    v_cvt_pk_bf16_f32 v217, v202, v203
    v_cvt_pk_bf16_f32 v218, v204, v205
    v_cvt_pk_bf16_f32 v219, v206, v207
    v_permlane16_swap_b32 v208, v210
    v_permlane16_swap_b32 v209, v211
    v_permlane16_swap_b32 v216, v218
    v_permlane16_swap_b32 v217, v219
    v_cvt_pk_bf16_f32 v240, v224, v225
    v_cvt_pk_bf16_f32 v241, v226, v227
    v_cvt_pk_bf16_f32 v242, v228, v229
    v_cvt_pk_bf16_f32 v243, v230, v231
    v_cvt_pk_bf16_f32 v248, v232, v233
    v_cvt_pk_bf16_f32 v249, v234, v235
    v_cvt_pk_bf16_f32 v250, v236, v237
    v_cvt_pk_bf16_f32 v251, v238, v239
    v_permlane16_swap_b32 v240, v242
    v_permlane16_swap_b32 v241, v243
    v_permlane16_swap_b32 v248, v250
    v_permlane16_swap_b32 v249, v251
    s_bitcmp1_b32 s31, 0
    s_cbranch_scc0 L_xds0
    s_mov_b32 s60, 0
L_lw_33:
    ds_read_b32 v3, v15 offset:0
    s_add_u32 s60, s60, 1
    s_cmp_gt_u32 s60, 1600000
    s_cbranch_scc1 L_lwo_34
    s_waitcnt lgkmcnt(0)
    v_cmp_eq_u32 vcc, 0, v3
    s_cbranch_vccnz L_lw_33
L_lwo_34:
    s_waitcnt lgkmcnt(0)
    s_add_u32 m0, s74, 0
    s_lshl_b32 s61, s14, s30
    buffer_load_dwordx4 v8, s[32:35], s61 offen sc1 lds
    s_add_u32 m0, m0, 1024
    s_nop 0
    buffer_load_dwordx4 v9, s[32:35], s61 offen sc1 lds
    s_add_u32 m0, s74, 4096
    s_lshl_b32 s61, s15, s30
    buffer_load_dwordx4 v8, s[32:35], s61 offen sc1 lds
    s_add_u32 m0, m0, 1024
    s_nop 0
    buffer_load_dwordx4 v9, s[32:35], s61 offen sc1 lds
L_xds0:
    s_mov_b32 s60, 0
L_lw_36:
    ds_read_b32 v3, v15 offset:48
    s_add_u32 s60, s60, 1
    s_cmp_gt_u32 s60, 1600000
    s_cbranch_scc1 L_lwo_37
    s_waitcnt lgkmcnt(0)
    v_cmp_eq_u32 vcc, 0, v3
    s_cbranch_vccnz L_lw_36
L_lwo_37:
    s_waitcnt lgkmcnt(0)
    buffer_store_dwordx4 v[176:179], v146, s[44:47], s40 offen offset:0 sc1
    buffer_store_dwordx4 v[184:187], v147, s[44:47], s40 offen offset:0 sc1
    buffer_store_dwordx4 v[208:211], v146, s[44:47], s41 offen offset:512 sc1
    buffer_store_dwordx4 v[216:219], v147, s[44:47], s41 offen offset:512 sc1
    buffer_store_dwordx4 v[240:243], v146, s[44:47], s42 offen offset:1024 sc1
    buffer_store_dwordx4 v[248:251], v147, s[44:47], s42 offen offset:1024 sc1
L_xg2:
    s_mov_b32 s60, 0
L_lw_39:
    ds_read_b32 v3, v15 offset:0
    s_add_u32 s60, s60, 1
    s_cmp_gt_u32 s60, 1600000
    s_cbranch_scc1 L_lwo_40
    s_waitcnt lgkmcnt(0)
    v_cmp_eq_u32 vcc, 0, v3
    s_cbranch_vccnz L_lw_39
L_lwo_40:
    s_waitcnt lgkmcnt(0)
    s_mov_b32 s60, 0
L_lw_42:
    ds_read_b32 v3, v15 offset:64
    s_add_u32 s60, s60, 1
    s_cmp_gt_u32 s60, 1600000
    s_cbranch_scc1 L_lwo_43
    s_waitcnt lgkmcnt(0)
    v_cmp_eq_u32 vcc, 0, v3
    s_cbranch_vccnz L_lw_42
L_lwo_43:
    s_waitcnt lgkmcnt(0)
    s_and_b32 s68, s75, 3
    s_lshl_b32 s64, s68, 7
    s_add_u32 s64, s64, 162816
    v_lshl_add_u32 v88, v1, 3, s64
    ds_read_b64 v[88:89], v88
    ds_read_b64_tr_b16 v[144:145], v4 offset:0
    ds_read_b64_tr_b16 v[146:147], v4 offset:512
    ds_read_b64_tr_b16 v[148:149], v5 offset:0
    ds_read_b64_tr_b16 v[150:151], v5 offset:512
    ds_read_b64_tr_b16 v[152:153], v6 offset:0
    ds_read_b64_tr_b16 v[154:155], v6 offset:512
    ds_read_b64_tr_b16 v[156:157], v7 offset:0
    ds_read_b64_tr_b16 v[158:159], v7 offset:512
    ds_read_b64_tr_b16 v[160:161], v4 offset:4096
    ds_read_b64_tr_b16 v[162:163], v4 offset:4608
    ds_read_b64_tr_b16 v[164:165], v5 offset:4096
    ds_read_b64_tr_b16 v[166:167], v5 offset:4608
    ds_read_b64_tr_b16 v[168:169], v6 offset:4096
    ds_read_b64_tr_b16 v[170:171], v6 offset:4608
    ds_read_b64_tr_b16 v[172:173], v7 offset:4096
    ds_read_b64_tr_b16 v[174:175], v7 offset:4608
    ds_read_b64_tr_b16 v[176:177], v4 offset:8192
    ds_read_b64_tr_b16 v[178:179], v4 offset:8704
    ds_read_b64_tr_b16 v[180:181], v5 offset:8192
    ds_read_b64_tr_b16 v[182:183], v5 offset:8704
    ds_read_b64_tr_b16 v[184:185], v6 offset:8192
    ds_read_b64_tr_b16 v[186:187], v6 offset:8704
    ds_read_b64_tr_b16 v[188:189], v7 offset:8192
    ds_read_b64_tr_b16 v[190:191], v7 offset:8704
    ds_read_b64_tr_b16 v[192:193], v4 offset:12288
    ds_read_b64_tr_b16 v[194:195], v4 offset:12800
    ds_read_b64_tr_b16 v[196:197], v5 offset:12288
    ds_read_b64_tr_b16 v[198:199], v5 offset:12800
    ds_read_b64_tr_b16 v[200:201], v6 offset:12288
    ds_read_b64_tr_b16 v[202:203], v6 offset:12800
    ds_read_b64_tr_b16 v[204:205], v7 offset:12288
    ds_read_b64_tr_b16 v[206:207], v7 offset:12800
    ds_read_b64_tr_b16 v[208:209], v4 offset:16384
    ds_read_b64_tr_b16 v[210:211], v4 offset:16896
    ds_read_b64_tr_b16 v[212:213], v5 offset:16384
    ds_read_b64_tr_b16 v[214:215], v5 offset:16896
    ds_read_b64_tr_b16 v[216:217], v6 offset:16384
    ds_read_b64_tr_b16 v[218:219], v6 offset:16896
    ds_read_b64_tr_b16 v[220:221], v7 offset:16384
    ds_read_b64_tr_b16 v[222:223], v7 offset:16896
    s_waitcnt lgkmcnt(0)
    ds_write_b32 v14, v13 offset:16
    s_mov_b32 s60, 0
L_lw_45:
    ds_read_b32 v3, v12 offset:16
    s_add_u32 s60, s60, 1
    s_cmp_gt_u32 s60, 1600000
    s_cbranch_scc1 L_lwo_46
    s_waitcnt lgkmcnt(0)
    v_cmp_eq_u32 vcc, 0, v3
    s_cbranch_vccnz L_lw_45
L_lwo_46:
    s_waitcnt lgkmcnt(0)
    s_waitcnt vmcnt(0)
    s_cmp_lg_u32 s48, 0
    s_cbranch_scc1 L_xsig2
    s_atomic_add s59, s[44:45], s65
    s_mov_b32 s48, 0x80000000
    s_cmp_eq_u32 s49, 0
    s_cbranch_scc1 L_hs_48
    s_atomic_add s59, s[44:45], s66
L_hs_48:
L_xsig2:
    s_setprio 3
    s_bitcmp1_b32 s31, 0
    s_cbranch_scc1 L_xds1
    s_add_u32 m0, s74, 0
    s_lshl_b32 s61, s14, s30
    buffer_load_dwordx4 v8, s[32:35], s61 offen sc1 lds
    s_add_u32 m0, m0, 1024
    s_nop 0
    buffer_load_dwordx4 v9, s[32:35], s61 offen sc1 lds
    s_add_u32 m0, s74, 4096
    s_lshl_b32 s61, s15, s30
    buffer_load_dwordx4 v8, s[32:35], s61 offen sc1 lds
    s_add_u32 m0, m0, 1024
    s_nop 0
    buffer_load_dwordx4 v9, s[32:35], s61 offen sc1 lds
L_xds1:
    s_and_b32 s68, s75, 3
    s_mul_i32 s64, s68, 6144
    s_add_u32 s64, s64, 0
    v_lshl_add_u32 v81, v0, 4, s64
    s_cmp_lg_u32 s63, 0
    s_cbranch_scc1 L_xno21
    s_add_u32 m0, s73, 158720
    s_lshl_b32 s61, s29, s30
    buffer_load_dwordx4 v8, s[32:35], s61 offen sc1 lds
    s_add_u32 m0, m0, 1024
    s_nop 0
    buffer_load_dwordx4 v9, s[32:35], s61 offen sc1 lds
L_xno21:
    s_xor_b32 s64, s68, 1
    s_mul_i32 s64, s64, 6144
    s_add_u32 s64, s64, 0
    v_lshl_add_u32 v80, v0, 4, s64
    s_add_u32 m0, s74, 8192
    s_lshl_b32 s61, s16, s30
    buffer_load_dwordx4 v8, s[32:35], s61 offen sc1 lds
    s_add_u32 m0, m0, 1024
    s_nop 0
    buffer_load_dwordx4 v9, s[32:35], s61 offen sc1 lds
    v_lshrrev_b32 v93, 2, v1
    v_lshl_add_u32 v93, v2, 2, v93
    v_bfe_u32 v82, v93, 1, 2
    v_xor_b32 v82, s68, v82
    v_lshlrev_b32 v82, 4, v82
    v_lshl_add_u32 v82, v93, 7, v82
    s_add_u32 m0, s74, 12288
    s_lshl_b32 s61, s17, s30
    buffer_load_dwordx4 v8, s[32:35], s61 offen sc1 lds
    s_add_u32 m0, m0, 1024
    s_nop 0
    buffer_load_dwordx4 v9, s[32:35], s61 offen sc1 lds
    v_bfe_u32 v93, v1, 1, 1
    v_lshl_add_u32 v82, v93, 6, v82
    v_and_b32 v93, 1, v1
    v_lshl_add_u32 v82, v93, 3, v82
    v_add_u32 v82, 122880, v82
    s_add_u32 m0, s74, 16384
    s_lshl_b32 s61, s18, s30
    buffer_load_dwordx4 v8, s[32:35], s61 offen sc1 lds
    s_add_u32 m0, m0, 1024
    s_nop 0
    buffer_load_dwordx4 v9, s[32:35], s61 offen sc1 lds
    v_lshrrev_b32 v83, 1, v2
    v_lshrrev_b32 v84, 1, v1
    v_xor_b32 v84, v84, v83
    v_lshlrev_b32 v84, 4, v84
    v_lshl_add_u32 v84, v1, 7, v84
    s_add_u32 m0, s74, 40960
    s_lshl_b32 s61, s19, s30
    buffer_load_dwordx4 v8, s[32:35], s61 offen sc1 lds
    s_add_u32 m0, m0, 1024
    s_nop 0
    buffer_load_dwordx4 v9, s[32:35], s61 offen sc1 lds
    v_and_b32 v92, 1, v2
    v_lshl_add_u32 v84, v92, 3, v84
    s_lshl_b32 s68, s68, 11
    s_add_u32 s68, s68, 131072
    v_add_u32 v84, s68, v84
    v_xor_b32 v85, 32, v84
    s_add_u32 m0, s74, 45056
    s_lshl_b32 s61, s20, s30
    buffer_load_dwordx4 v8, s[32:35], s61 offen sc1 lds
    s_add_u32 m0, m0, 1024
    s_nop 0
    buffer_load_dwordx4 v9, s[32:35], s61 offen sc1 lds
    v_lshl_add_u32 v92, v92, 1, v83
    v_bfe_u32 v93, v1, 1, 2
    v_xor_b32 v92, v92, v93
    v_lshlrev_b32 v92, 4, v92
    v_lshl_add_u32 v92, v1, 6, v92
    s_add_u32 m0, s74, 49152
    s_lshl_b32 s61, s21, s30
    buffer_load_dwordx4 v8, s[32:35], s61 offen sc1 lds
    s_add_u32 m0, m0, 1024
    s_nop 0
    buffer_load_dwordx4 v9, s[32:35], s61 offen sc1 lds
    s_lshl_b32 s68, s3, 10
    s_add_u32 s68, s68, 24576
    v_add_u32 v86, s68, v92
    v_lshl_add_u32 v87, v0, 4, s68
    s_add_u32 m0, s74, 53248
    s_lshl_b32 s61, s22, s30
    buffer_load_dwordx4 v8, s[32:35], s61 offen sc1 lds
    s_add_u32 m0, m0, 1024
    s_nop 0
    buffer_load_dwordx4 v9, s[32:35], s61 offen sc1 lds
    s_lshl_b32 s64, s75, 14
    s_lshl_b32 s68, s56, 7
    s_add_u32 s64, s64, s68
    s_add_u32 s64, s64, 0
    v_bfe_u32 v93, v0, 3, 2
    v_xor_b32 v93, v93, v0
    v_and_b32 v93, 3, v93
    v_lshl_add_u32 v83, v93, 4, s64
    v_lshrrev_b32 v93, 2, v0
    v_lshl_add_u32 v83, v93, 10, v83
    s_add_u32 m0, s74, 57344
    s_lshl_b32 s61, s23, s30
    buffer_load_dwordx4 v8, s[32:35], s61 offen sc1 lds
    s_add_u32 m0, m0, 1024
    s_nop 0
    buffer_load_dwordx4 v9, s[32:35], s61 offen sc1 lds
    v_mul_f32 v91, v89, v89
    v_mul_f32 v90, v91, v89
    v_mul_f32 v91, 0xbfb8aa3b, v91
    s_add_u32 m0, s74, 81920
    s_lshl_b32 s61, s24, s30
    buffer_load_dwordx4 v8, s[32:35], s61 offen sc1 lds
    s_add_u32 m0, m0, 1024
    s_nop 0
    buffer_load_dwordx4 v9, s[32:35], s61 offen sc1 lds
    s_mov_b32 s58, 0
    s_atomic_add s58, s[44:45], s67 glc
    s_add_u32 m0, s74, 86016
    s_lshl_b32 s61, s25, s30
    buffer_load_dwordx4 v8, s[32:35], s61 offen sc1 lds
    s_add_u32 m0, m0, 1024
    s_nop 0
    buffer_load_dwordx4 v9, s[32:35], s61 offen sc1 lds
    s_add_u32 m0, s74, 90112
    s_lshl_b32 s61, s26, s30
    buffer_load_dwordx4 v8, s[32:35], s61 offen sc1 lds
    s_add_u32 m0, m0, 1024
    s_nop 0
    buffer_load_dwordx4 v9, s[32:35], s61 offen sc1 lds
    s_add_u32 m0, s74, 94208
    s_lshl_b32 s61, s27, s30
    buffer_load_dwordx4 v8, s[32:35], s61 offen sc1 lds
    s_add_u32 m0, m0, 1024
    s_nop 0
    buffer_load_dwordx4 v9, s[32:35], s61 offen sc1 lds
    s_add_u32 m0, s74, 98304
    s_lshl_b32 s61, s28, s30
    buffer_load_dwordx4 v8, s[32:35], s61 offen sc1 lds
    s_add_u32 m0, m0, 1024
    s_nop 0
    buffer_load_dwordx4 v9, s[32:35], s61 offen sc1 lds
    s_mov_b32 vcc_lo, 0
L_sp_49:
    s_waitcnt lgkmcnt(0)
    s_cmp_ge_u32 s58, 15
    s_cbranch_scc1 L_spo_50
    s_sleep 1
    s_mov_b32 s58, 0
    s_atomic_add s58, s[44:45], s67 glc
    s_add_u32 vcc_lo, vcc_lo, 1
    s_cmp_lt_u32 vcc_lo, 200000
    s_cbranch_scc1 L_sp_49
    s_waitcnt lgkmcnt(0)
L_spo_50:
    buffer_load_dwordx4 v[16:19], v10, s[44:47], s8 offen sc1
    buffer_load_dwordx4 v[20:23], v11, s[44:47], s8 offen sc1
    buffer_load_dwordx4 v[24:27], v10, s[44:47], s9 offen sc1
    buffer_load_dwordx4 v[28:31], v11, s[44:47], s9 offen sc1
    buffer_load_dwordx4 v[32:35], v10, s[44:47], s10 offen sc1
    buffer_load_dwordx4 v[36:39], v11, s[44:47], s10 offen sc1
    buffer_load_dwordx4 v[40:43], v10, s[44:47], s11 offen sc1
    buffer_load_dwordx4 v[44:47], v11, s[44:47], s11 offen sc1
    buffer_load_dwordx4 v[48:51], v10, s[44:47], s12 offen sc1
    buffer_load_dwordx4 v[52:55], v11, s[44:47], s12 offen sc1
L_xmixed:
    s_setprio 1
    s_waitcnt vmcnt(10)
    ds_write_b32 v14, v13 offset:32
    s_waitcnt vmcnt(8)
    v_mfma_f32_16x16x32_bf16 v[240:243], v[144:147], v[20:23], 0
    v_mfma_f32_16x16x32_bf16 v[244:247], v[148:151], v[20:23], 0
    buffer_load_dwordx4 v[56:59], v10, s[44:47], s13 offen sc1
    v_mfma_f32_16x16x32_bf16 v[248:251], v[152:155], v[20:23], 0
    v_mfma_f32_16x16x32_bf16 v[252:255], v[156:159], v[20:23], 0
    v_mfma_f32_16x16x32_bf16 v[236:239], v[156:159], v[16:19], 0
    v_mfma_f32_16x16x32_bf16 v[232:235], v[152:155], v[16:19], 0
    buffer_load_dwordx4 v[60:63], v11, s[44:47], s13 offen sc1
    v_mfma_f32_16x16x32_bf16 v[228:231], v[148:151], v[16:19], 0
    v_mfma_f32_16x16x32_bf16 v[224:227], v[144:147], v[16:19], 0
    s_waitcnt vmcnt(8)
    v_mfma_f32_16x16x32_bf16 v[224:227], v[160:163], v[24:27], v[224:227]
    v_mfma_f32_16x16x32_bf16 v[228:231], v[164:167], v[24:27], v[228:231]
    buffer_load_dwordx4 v[64:67], v10, s[44:47], s14 offen sc1
    v_mfma_f32_16x16x32_bf16 v[232:235], v[168:171], v[24:27], v[232:235]
    v_mfma_f32_16x16x32_bf16 v[236:239], v[172:175], v[24:27], v[236:239]
    v_mfma_f32_16x16x32_bf16 v[252:255], v[172:175], v[28:31], v[252:255]
    v_mfma_f32_16x16x32_bf16 v[248:251], v[168:171], v[28:31], v[248:251]
    buffer_load_dwordx4 v[68:71], v11, s[44:47], s14 offen sc1
    v_mfma_f32_16x16x32_bf16 v[244:247], v[164:167], v[28:31], v[244:247]
    v_mfma_f32_16x16x32_bf16 v[240:243], v[160:163], v[28:31], v[240:243]
    s_waitcnt vmcnt(8)
    v_mfma_f32_16x16x32_bf16 v[240:243], v[176:179], v[36:39], v[240:243]
    v_mfma_f32_16x16x32_bf16 v[244:247], v[180:183], v[36:39], v[244:247]
    buffer_load_dwordx4 v[72:75], v10, s[44:47], s15 offen sc1
    v_mfma_f32_16x16x32_bf16 v[248:251], v[184:187], v[36:39], v[248:251]
    ds_read_b32 v3, v15 offset:32
    v_mfma_f32_16x16x32_bf16 v[252:255], v[188:191], v[36:39], v[252:255]
    v_mfma_f32_16x16x32_bf16 v[236:239], v[188:191], v[32:35], v[236:239]
    v_mfma_f32_16x16x32_bf16 v[232:235], v[184:187], v[32:35], v[232:235]
    buffer_load_dwordx4 v[76:79], v11, s[44:47], s15 offen sc1
    v_mfma_f32_16x16x32_bf16 v[228:231], v[180:183], v[32:35], v[228:231]
    s_waitcnt lgkmcnt(0)
    v_cmp_eq_u32 vcc, 0, v3
    v_mfma_f32_16x16x32_bf16 v[224:227], v[176:179], v[32:35], v[224:227]
    s_cbranch_vccnz L_slow_xdma
L_back_xdma:
    s_waitcnt vmcnt(8)
    v_mfma_f32_16x16x32_bf16 v[224:227], v[192:195], v[40:43], v[224:227]
    v_add_u32 v4, s71, v4
    ds_read_b64_tr_b16 v[112:113], v4 offset:0
    v_mfma_f32_16x16x32_bf16 v[228:231], v[196:199], v[40:43], v[228:231]
    ds_read_b64_tr_b16 v[114:115], v4 offset:512
    buffer_load_dwordx4 v[16:19], v10, s[44:47], s16 offen sc1
    v_mfma_f32_16x16x32_bf16 v[232:235], v[200:203], v[40:43], v[232:235]
    v_add_u32 v5, s71, v5
    ds_read_b64_tr_b16 v[116:117], v5 offset:0
    v_mfma_f32_16x16x32_bf16 v[236:239], v[204:207], v[40:43], v[236:239]
    ds_read_b64_tr_b16 v[118:119], v5 offset:512
    v_mfma_f32_16x16x32_bf16 v[252:255], v[204:207], v[44:47], v[252:255]
    v_add_u32 v6, s71, v6
    ds_read_b64_tr_b16 v[120:121], v6 offset:0
    v_mfma_f32_16x16x32_bf16 v[248:251], v[200:203], v[44:47], v[248:251]
    ds_read_b64_tr_b16 v[122:123], v6 offset:512
    buffer_load_dwordx4 v[20:23], v11, s[44:47], s16 offen sc1
    v_mfma_f32_16x16x32_bf16 v[244:247], v[196:199], v[44:47], v[244:247]
    v_add_u32 v7, s71, v7
    ds_read_b64_tr_b16 v[124:125], v7 offset:0
    v_mfma_f32_16x16x32_bf16 v[240:243], v[192:195], v[44:47], v[240:243]
    ds_read_b64_tr_b16 v[126:127], v7 offset:512
    s_waitcnt vmcnt(8)
    v_mfma_f32_16x16x32_bf16 v[240:243], v[208:211], v[52:55], v[240:243]
    v_subrev_u32 v4, s70, v4
    ds_read_b64_tr_b16 v[128:129], v4 offset:0
    v_mfma_f32_16x16x32_bf16 v[244:247], v[212:215], v[52:55], v[244:247]
    ds_read_b64_tr_b16 v[130:131], v4 offset:512
    buffer_load_dwordx4 v[24:27], v10, s[44:47], s17 offen sc1
    v_mfma_f32_16x16x32_bf16 v[248:251], v[216:219], v[52:55], v[248:251]
    v_subrev_u32 v5, s70, v5
    ds_read_b64_tr_b16 v[132:133], v5 offset:0
    v_mfma_f32_16x16x32_bf16 v[252:255], v[220:223], v[52:55], v[252:255]
    ds_read_b64_tr_b16 v[134:135], v5 offset:512
    v_mfma_f32_16x16x32_bf16 v[236:239], v[220:223], v[48:51], v[236:239]
    v_subrev_u32 v6, s70, v6
    ds_read_b64_tr_b16 v[136:137], v6 offset:0
    v_mfma_f32_16x16x32_bf16 v[232:235], v[216:219], v[48:51], v[232:235]
    ds_read_b64_tr_b16 v[138:139], v6 offset:512
    buffer_load_dwordx4 v[28:31], v11, s[44:47], s17 offen sc1
    v_mfma_f32_16x16x32_bf16 v[228:231], v[212:215], v[48:51], v[228:231]
    v_subrev_u32 v7, s70, v7
    ds_read_b64_tr_b16 v[140:141], v7 offset:0
    v_mfma_f32_16x16x32_bf16 v[224:227], v[208:211], v[48:51], v[224:227]
    ds_read_b64_tr_b16 v[142:143], v7 offset:512
    s_waitcnt vmcnt(8) lgkmcnt(8)
    v_mfma_f32_16x16x32_bf16 v[224:227], v[112:115], v[56:59], v[224:227]
    ds_read_b64_tr_b16 v[192:193], v4 offset:4096
    v_mfma_f32_16x16x32_bf16 v[228:231], v[116:119], v[56:59], v[228:231]
    ds_read_b64_tr_b16 v[194:195], v4 offset:4608
    buffer_load_dwordx4 v[32:35], v10, s[44:47], s18 offen sc1
    v_mfma_f32_16x16x32_bf16 v[232:235], v[120:123], v[56:59], v[232:235]
    ds_read_b64_tr_b16 v[196:197], v5 offset:4096
    v_mfma_f32_16x16x32_bf16 v[236:239], v[124:127], v[56:59], v[236:239]
    ds_read_b64_tr_b16 v[198:199], v5 offset:4608
    v_mfma_f32_16x16x32_bf16 v[252:255], v[124:127], v[60:63], v[252:255]
    ds_read_b64_tr_b16 v[200:201], v6 offset:4096
    v_mfma_f32_16x16x32_bf16 v[248:251], v[120:123], v[60:63], v[248:251]
    ds_read_b64_tr_b16 v[202:203], v6 offset:4608
    buffer_load_dwordx4 v[36:39], v11, s[44:47], s18 offen sc1
    v_mfma_f32_16x16x32_bf16 v[244:247], v[116:119], v[60:63], v[244:247]
    ds_read_b64_tr_b16 v[204:205], v7 offset:4096
    v_mfma_f32_16x16x32_bf16 v[240:243], v[112:115], v[60:63], v[240:243]
    ds_read_b64_tr_b16 v[206:207], v7 offset:4608
    s_waitcnt vmcnt(8) lgkmcnt(8)
    v_mfma_f32_16x16x32_bf16 v[240:243], v[128:131], v[68:71], v[240:243]
    ds_read_b64_tr_b16 v[112:113], v4 offset:8192
    v_mfma_f32_16x16x32_bf16 v[244:247], v[132:135], v[68:71], v[244:247]
    ds_read_b64_tr_b16 v[114:115], v4 offset:8704
    buffer_load_dwordx4 v[40:43], v10, s[44:47], s19 offen sc1
    v_mfma_f32_16x16x32_bf16 v[248:251], v[136:139], v[68:71], v[248:251]
    ds_read_b64_tr_b16 v[116:117], v5 offset:8192
    v_mfma_f32_16x16x32_bf16 v[252:255], v[140:143], v[68:71], v[252:255]
    ds_read_b64_tr_b16 v[118:119], v5 offset:8704
    v_mfma_f32_16x16x32_bf16 v[236:239], v[140:143], v[64:67], v[236:239]
    ds_read_b64_tr_b16 v[120:121], v6 offset:8192
    v_mfma_f32_16x16x32_bf16 v[232:235], v[136:139], v[64:67], v[232:235]
    ds_read_b64_tr_b16 v[122:123], v6 offset:8704
    buffer_load_dwordx4 v[44:47], v11, s[44:47], s19 offen sc1
    v_mfma_f32_16x16x32_bf16 v[228:231], v[132:135], v[64:67], v[228:231]
    ds_read_b64_tr_b16 v[124:125], v7 offset:8192
    v_mfma_f32_16x16x32_bf16 v[224:227], v[128:131], v[64:67], v[224:227]
    ds_read_b64_tr_b16 v[126:127], v7 offset:8704
    s_waitcnt vmcnt(8) lgkmcnt(8)
    v_mfma_f32_16x16x32_bf16 v[224:227], v[192:195], v[72:75], v[224:227]
    ds_read_b64_tr_b16 v[128:129], v4 offset:12288
    v_mfma_f32_16x16x32_bf16 v[228:231], v[196:199], v[72:75], v[228:231]
    ds_read_b64_tr_b16 v[130:131], v4 offset:12800
    buffer_load_dwordx4 v[48:51], v10, s[44:47], s20 offen sc1
    v_mfma_f32_16x16x32_bf16 v[232:235], v[200:203], v[72:75], v[232:235]
    ds_read_b64_tr_b16 v[132:133], v5 offset:12288
    v_mfma_f32_16x16x32_bf16 v[236:239], v[204:207], v[72:75], v[236:239]
    ds_read_b64_tr_b16 v[134:135], v5 offset:12800
    v_mfma_f32_16x16x32_bf16 v[252:255], v[204:207], v[76:79], v[252:255]
    ds_read_b64_tr_b16 v[136:137], v6 offset:12288
    v_mfma_f32_16x16x32_bf16 v[248:251], v[200:203], v[76:79], v[248:251]
    ds_read_b64_tr_b16 v[138:139], v6 offset:12800
    buffer_load_dwordx4 v[52:55], v11, s[44:47], s20 offen sc1
    v_mfma_f32_16x16x32_bf16 v[244:247], v[196:199], v[76:79], v[244:247]
    ds_read_b64_tr_b16 v[140:141], v7 offset:12288
    v_mfma_f32_16x16x32_bf16 v[240:243], v[192:195], v[76:79], v[240:243]
    ds_read_b64_tr_b16 v[142:143], v7 offset:12800
    s_waitcnt vmcnt(8) lgkmcnt(8)
    v_mfma_f32_16x16x32_bf16 v[240:243], v[112:115], v[20:23], v[240:243]
    ds_read_b64_tr_b16 v[192:193], v4 offset:16384
    v_mfma_f32_16x16x32_bf16 v[244:247], v[116:119], v[20:23], v[244:247]
    ds_read_b64_tr_b16 v[194:195], v4 offset:16896
    buffer_load_dwordx4 v[56:59], v10, s[44:47], s21 offen sc1
    v_mfma_f32_16x16x32_bf16 v[248:251], v[120:123], v[20:23], v[248:251]
    ds_read_b64_tr_b16 v[196:197], v5 offset:16384
    v_mfma_f32_16x16x32_bf16 v[252:255], v[124:127], v[20:23], v[252:255]
    ds_read_b64_tr_b16 v[198:199], v5 offset:16896
    v_mfma_f32_16x16x32_bf16 v[236:239], v[124:127], v[16:19], v[236:239]
    ds_read_b64_tr_b16 v[200:201], v6 offset:16384
    v_mfma_f32_16x16x32_bf16 v[232:235], v[120:123], v[16:19], v[232:235]
    ds_read_b64_tr_b16 v[202:203], v6 offset:16896
    buffer_load_dwordx4 v[60:63], v11, s[44:47], s21 offen sc1
    v_mfma_f32_16x16x32_bf16 v[228:231], v[116:119], v[16:19], v[228:231]
    ds_read_b64_tr_b16 v[204:205], v7 offset:16384
    v_mfma_f32_16x16x32_bf16 v[224:227], v[112:115], v[16:19], v[224:227]
    ds_read_b64_tr_b16 v[206:207], v7 offset:16896
    s_waitcnt vmcnt(8) lgkmcnt(8)
    v_mfma_f32_16x16x32_bf16 v[224:227], v[128:131], v[24:27], v[224:227]
    ds_read_b64_tr_b16 v[112:113], v4 offset:40960
    v_mfma_f32_16x16x32_bf16 v[228:231], v[132:135], v[24:27], v[228:231]
    ds_read_b64_tr_b16 v[114:115], v4 offset:41472
    buffer_load_dwordx4 v[64:67], v10, s[44:47], s22 offen sc1
    v_mfma_f32_16x16x32_bf16 v[232:235], v[136:139], v[24:27], v[232:235]
    ds_read_b64_tr_b16 v[116:117], v5 offset:40960
    v_mfma_f32_16x16x32_bf16 v[236:239], v[140:143], v[24:27], v[236:239]
    ds_read_b64_tr_b16 v[118:119], v5 offset:41472
    v_mfma_f32_16x16x32_bf16 v[252:255], v[140:143], v[28:31], v[252:255]
    ds_read_b64_tr_b16 v[120:121], v6 offset:40960
    v_mfma_f32_16x16x32_bf16 v[248:251], v[136:139], v[28:31], v[248:251]
    ds_read_b64_tr_b16 v[122:123], v6 offset:41472
    buffer_load_dwordx4 v[68:71], v11, s[44:47], s22 offen sc1
    v_mfma_f32_16x16x32_bf16 v[244:247], v[132:135], v[28:31], v[244:247]
    ds_read_b64_tr_b16 v[124:125], v7 offset:40960
    v_mfma_f32_16x16x32_bf16 v[240:243], v[128:131], v[28:31], v[240:243]
    ds_read_b64_tr_b16 v[126:127], v7 offset:41472
    s_waitcnt vmcnt(8) lgkmcnt(8)
    v_mfma_f32_16x16x32_bf16 v[240:243], v[192:195], v[36:39], v[240:243]
    ds_read_b64_tr_b16 v[128:129], v4 offset:45056
    ds_write_b32 v14, v13 offset:144
    v_mfma_f32_16x16x32_bf16 v[244:247], v[196:199], v[36:39], v[244:247]
    ds_read_b64_tr_b16 v[130:131], v4 offset:45568
    buffer_load_dwordx4 v[72:75], v10, s[44:47], s23 offen sc1
    v_mfma_f32_16x16x32_bf16 v[248:251], v[200:203], v[36:39], v[248:251]
    ds_read_b64_tr_b16 v[132:133], v5 offset:45056
    v_mfma_f32_16x16x32_bf16 v[252:255], v[204:207], v[36:39], v[252:255]
    ds_read_b64_tr_b16 v[134:135], v5 offset:45568
    v_mfma_f32_16x16x32_bf16 v[236:239], v[204:207], v[32:35], v[236:239]
    ds_read_b64_tr_b16 v[136:137], v6 offset:45056
    v_mfma_f32_16x16x32_bf16 v[232:235], v[200:203], v[32:35], v[232:235]
    ds_read_b64_tr_b16 v[138:139], v6 offset:45568
    buffer_load_dwordx4 v[76:79], v11, s[44:47], s23 offen sc1
    v_mfma_f32_16x16x32_bf16 v[228:231], v[196:199], v[32:35], v[228:231]
    ds_read_b64_tr_b16 v[140:141], v7 offset:45056
    v_mfma_f32_16x16x32_bf16 v[224:227], v[192:195], v[32:35], v[224:227]
    ds_read_b64_tr_b16 v[142:143], v7 offset:45568
    s_waitcnt vmcnt(8) lgkmcnt(9)
    v_mfma_f32_16x16x32_bf16 v[224:227], v[112:115], v[40:43], v[224:227]
    ds_read_b64_tr_b16 v[192:193], v4 offset:49152
    v_mfma_f32_16x16x32_bf16 v[228:231], v[116:119], v[40:43], v[228:231]
    ds_read_b64_tr_b16 v[194:195], v4 offset:49664
    buffer_load_dwordx4 v[16:19], v10, s[44:47], s24 offen sc1
    v_mfma_f32_16x16x32_bf16 v[232:235], v[120:123], v[40:43], v[232:235]
    ds_read_b64_tr_b16 v[196:197], v5 offset:49152
    v_mfma_f32_16x16x32_bf16 v[236:239], v[124:127], v[40:43], v[236:239]
    ds_read_b64_tr_b16 v[198:199], v5 offset:49664
    v_mfma_f32_16x16x32_bf16 v[252:255], v[124:127], v[44:47], v[252:255]
    ds_read_b64_tr_b16 v[200:201], v6 offset:49152
    v_mfma_f32_16x16x32_bf16 v[248:251], v[120:123], v[44:47], v[248:251]
    ds_read_b64_tr_b16 v[202:203], v6 offset:49664
    buffer_load_dwordx4 v[20:23], v11, s[44:47], s24 offen sc1
    v_mfma_f32_16x16x32_bf16 v[244:247], v[116:119], v[44:47], v[244:247]
    ds_read_b64_tr_b16 v[204:205], v7 offset:49152
    v_mfma_f32_16x16x32_bf16 v[240:243], v[112:115], v[44:47], v[240:243]
    ds_read_b64_tr_b16 v[206:207], v7 offset:49664
    s_waitcnt vmcnt(8) lgkmcnt(8)
    v_mfma_f32_16x16x32_bf16 v[240:243], v[128:131], v[52:55], v[240:243]
    ds_read_b64_tr_b16 v[112:113], v4 offset:53248
    v_mfma_f32_16x16x32_bf16 v[244:247], v[132:135], v[52:55], v[244:247]
    ds_read_b64_tr_b16 v[114:115], v4 offset:53760
    buffer_load_dwordx4 v[24:27], v10, s[44:47], s25 offen sc1
    v_mfma_f32_16x16x32_bf16 v[248:251], v[136:139], v[52:55], v[248:251]
    ds_read_b64_tr_b16 v[116:117], v5 offset:53248
    v_mfma_f32_16x16x32_bf16 v[252:255], v[140:143], v[52:55], v[252:255]
    ds_read_b64_tr_b16 v[118:119], v5 offset:53760
    v_mfma_f32_16x16x32_bf16 v[236:239], v[140:143], v[48:51], v[236:239]
    ds_read_b64_tr_b16 v[120:121], v6 offset:53248
    v_mfma_f32_16x16x32_bf16 v[232:235], v[136:139], v[48:51], v[232:235]
    ds_read_b64_tr_b16 v[122:123], v6 offset:53760
    buffer_load_dwordx4 v[28:31], v11, s[44:47], s25 offen sc1
    v_mfma_f32_16x16x32_bf16 v[228:231], v[132:135], v[48:51], v[228:231]
    ds_read_b64_tr_b16 v[124:125], v7 offset:53248
    v_mfma_f32_16x16x32_bf16 v[224:227], v[128:131], v[48:51], v[224:227]
    ds_read_b64_tr_b16 v[126:127], v7 offset:53760
    s_waitcnt vmcnt(8) lgkmcnt(8)
    v_mfma_f32_16x16x32_bf16 v[224:227], v[192:195], v[56:59], v[224:227]
    ds_read_b64_tr_b16 v[128:129], v4 offset:57344
    v_mfma_f32_16x16x32_bf16 v[228:231], v[196:199], v[56:59], v[228:231]
    ds_read_b64_tr_b16 v[130:131], v4 offset:57856
    buffer_load_dwordx4 v[32:35], v10, s[44:47], s26 offen sc1
    v_mfma_f32_16x16x32_bf16 v[232:235], v[200:203], v[56:59], v[232:235]
    ds_read_b64_tr_b16 v[132:133], v5 offset:57344
    v_mfma_f32_16x16x32_bf16 v[236:239], v[204:207], v[56:59], v[236:239]
    ds_read_b64_tr_b16 v[134:135], v5 offset:57856
    v_mfma_f32_16x16x32_bf16 v[252:255], v[204:207], v[60:63], v[252:255]
    ds_read_b64_tr_b16 v[136:137], v6 offset:57344
    v_mfma_f32_16x16x32_bf16 v[248:251], v[200:203], v[60:63], v[248:251]
    ds_read_b64_tr_b16 v[138:139], v6 offset:57856
    buffer_load_dwordx4 v[36:39], v11, s[44:47], s26 offen sc1
    v_mfma_f32_16x16x32_bf16 v[244:247], v[196:199], v[60:63], v[244:247]
    ds_read_b64_tr_b16 v[140:141], v7 offset:57344
    ds_write_b32 v14, v13 offset:208
    v_mfma_f32_16x16x32_bf16 v[240:243], v[192:195], v[60:63], v[240:243]
    ds_read_b64_tr_b16 v[142:143], v7 offset:57856
    s_waitcnt vmcnt(8) lgkmcnt(9)
    v_mfma_f32_16x16x32_bf16 v[240:243], v[112:115], v[68:71], v[240:243]
    v_add_u32 v4, 81920, v4
    ds_read_b64_tr_b16 v[192:193], v4 offset:0
    v_mfma_f32_16x16x32_bf16 v[244:247], v[116:119], v[68:71], v[244:247]
    ds_read_b64_tr_b16 v[194:195], v4 offset:512
    buffer_load_dwordx4 v[40:43], v10, s[44:47], s27 offen sc1
    v_mfma_f32_16x16x32_bf16 v[248:251], v[120:123], v[68:71], v[248:251]
    v_add_u32 v5, 81920, v5
    ds_read_b64_tr_b16 v[196:197], v5 offset:0
    v_mfma_f32_16x16x32_bf16 v[252:255], v[124:127], v[68:71], v[252:255]
    ds_read_b64_tr_b16 v[198:199], v5 offset:512
    v_mfma_f32_16x16x32_bf16 v[236:239], v[124:127], v[64:67], v[236:239]
    v_add_u32 v6, 81920, v6
    ds_read_b64_tr_b16 v[200:201], v6 offset:0
    v_mfma_f32_16x16x32_bf16 v[232:235], v[120:123], v[64:67], v[232:235]
    ds_read_b64_tr_b16 v[202:203], v6 offset:512
    buffer_load_dwordx4 v[44:47], v11, s[44:47], s27 offen sc1
    v_mfma_f32_16x16x32_bf16 v[228:231], v[116:119], v[64:67], v[228:231]
    v_add_u32 v7, 81920, v7
    ds_read_b64_tr_b16 v[204:205], v7 offset:0
    v_mfma_f32_16x16x32_bf16 v[224:227], v[112:115], v[64:67], v[224:227]
    ds_read_b64_tr_b16 v[206:207], v7 offset:512
    s_waitcnt vmcnt(8) lgkmcnt(8)
    v_mfma_f32_16x16x32_bf16 v[224:227], v[128:131], v[72:75], v[224:227]
    ds_read_b64_tr_b16 v[112:113], v4 offset:4096
    v_mfma_f32_16x16x32_bf16 v[228:231], v[132:135], v[72:75], v[228:231]
    ds_read_b64_tr_b16 v[114:115], v4 offset:4608
    buffer_load_dwordx4 v[48:51], v10, s[44:47], s28 offen sc1
    v_mfma_f32_16x16x32_bf16 v[232:235], v[136:139], v[72:75], v[232:235]
    ds_read_b64_tr_b16 v[116:117], v5 offset:4096
    v_mfma_f32_16x16x32_bf16 v[236:239], v[140:143], v[72:75], v[236:239]
    ds_read_b64_tr_b16 v[118:119], v5 offset:4608
    v_mfma_f32_16x16x32_bf16 v[252:255], v[140:143], v[76:79], v[252:255]
    ds_read_b64_tr_b16 v[120:121], v6 offset:4096
    v_mfma_f32_16x16x32_bf16 v[248:251], v[136:139], v[76:79], v[248:251]
    ds_read_b64_tr_b16 v[122:123], v6 offset:4608
    buffer_load_dwordx4 v[52:55], v11, s[44:47], s28 offen sc1
    v_mfma_f32_16x16x32_bf16 v[244:247], v[132:135], v[76:79], v[244:247]
    ds_read_b64_tr_b16 v[124:125], v7 offset:4096
    v_mfma_f32_16x16x32_bf16 v[240:243], v[128:131], v[76:79], v[240:243]
    ds_read_b64_tr_b16 v[126:127], v7 offset:4608
    s_waitcnt vmcnt(8) lgkmcnt(8)
    v_mfma_f32_16x16x32_bf16 v[240:243], v[192:195], v[20:23], v[240:243]
    ds_read_b64_tr_b16 v[128:129], v4 offset:8192
    v_mfma_f32_16x16x32_bf16 v[244:247], v[196:199], v[20:23], v[244:247]
    ds_read_b64_tr_b16 v[130:131], v4 offset:8704
    buffer_load_dwordx4 v[56:59], v10, s[44:47], s29 offen sc1
    v_mfma_f32_16x16x32_bf16 v[248:251], v[200:203], v[20:23], v[248:251]
    ds_read_b64_tr_b16 v[132:133], v5 offset:8192
    v_mfma_f32_16x16x32_bf16 v[252:255], v[204:207], v[20:23], v[252:255]
    ds_read_b64_tr_b16 v[134:135], v5 offset:8704
    v_mfma_f32_16x16x32_bf16 v[236:239], v[204:207], v[16:19], v[236:239]
    ds_read_b64_tr_b16 v[136:137], v6 offset:8192
    v_mfma_f32_16x16x32_bf16 v[232:235], v[200:203], v[16:19], v[232:235]
    ds_read_b64_tr_b16 v[138:139], v6 offset:8704
    buffer_load_dwordx4 v[60:63], v11, s[44:47], s29 offen sc1
    v_mfma_f32_16x16x32_bf16 v[228:231], v[196:199], v[16:19], v[228:231]
    ds_read_b64_tr_b16 v[140:141], v7 offset:8192
    v_mfma_f32_16x16x32_bf16 v[224:227], v[192:195], v[16:19], v[224:227]
    ds_read_b64_tr_b16 v[142:143], v7 offset:8704
    s_waitcnt vmcnt(8) lgkmcnt(8)
    v_mfma_f32_16x16x32_bf16 v[224:227], v[112:115], v[24:27], v[224:227]
    ds_read_b64_tr_b16 v[192:193], v4 offset:12288
    ds_read2_b32 v[92:93], v15 offset0:36 offset1:48
    v_mfma_f32_16x16x32_bf16 v[228:231], v[116:119], v[24:27], v[228:231]
    ds_read_b64_tr_b16 v[194:195], v4 offset:12800
    v_mfma_f32_16x16x32_bf16 v[232:235], v[120:123], v[24:27], v[232:235]
    ds_read_b64_tr_b16 v[196:197], v5 offset:12288
    v_mfma_f32_16x16x32_bf16 v[236:239], v[124:127], v[24:27], v[236:239]
    ds_read_b64_tr_b16 v[198:199], v5 offset:12800
    v_mfma_f32_16x16x32_bf16 v[252:255], v[124:127], v[28:31], v[252:255]
    ds_read_b64_tr_b16 v[200:201], v6 offset:12288
    s_waitcnt lgkmcnt(4)
    v_and_b32 v3, v92, v93
    v_mfma_f32_16x16x32_bf16 v[248:251], v[120:123], v[28:31], v[248:251]
    ds_read_b64_tr_b16 v[202:203], v6 offset:12800
    v_mfma_f32_16x16x32_bf16 v[244:247], v[116:119], v[28:31], v[244:247]
    ds_read_b64_tr_b16 v[204:205], v7 offset:12288
    v_cmp_eq_u32 vcc, 0, v3
    v_mfma_f32_16x16x32_bf16 v[240:243], v[112:115], v[28:31], v[240:243]
    ds_read_b64_tr_b16 v[206:207], v7 offset:12800
    s_cbranch_vccnz L_slow_fin
L_back_fin:
    s_waitcnt vmcnt(6)
    v_mfma_f32_16x16x32_bf16 v[240:243], v[128:131], v[36:39], v[240:243]
    ds_read_b64_tr_b16 v[112:113], v4 offset:16384
    ds_read_b64 v[96:97], v84
    v_mfma_f32_16x16x32_bf16 v[244:247], v[132:135], v[36:39], v[244:247]
    ds_read_b64_tr_b16 v[114:115], v4 offset:16896
    v_mfma_f32_16x16x32_bf16 v[248:251], v[136:139], v[36:39], v[248:251]
    ds_read_b64_tr_b16 v[116:117], v5 offset:16384
    v_mfma_f32_16x16x32_bf16 v[252:255], v[140:143], v[36:39], v[252:255]
    ds_read_b64_tr_b16 v[118:119], v5 offset:16896
    ds_read_b64 v[98:99], v85
    v_mfma_f32_16x16x32_bf16 v[236:239], v[140:143], v[32:35], v[236:239]
    ds_read_b64_tr_b16 v[120:121], v6 offset:16384
    v_mfma_f32_16x16x32_bf16 v[232:235], v[136:139], v[32:35], v[232:235]
    ds_read_b64_tr_b16 v[122:123], v6 offset:16896
    v_mfma_f32_16x16x32_bf16 v[228:231], v[132:135], v[32:35], v[228:231]
    ds_read_b64_tr_b16 v[124:125], v7 offset:16384
    v_mfma_f32_16x16x32_bf16 v[224:227], v[128:131], v[32:35], v[224:227]
    ds_read_b64_tr_b16 v[126:127], v7 offset:16896
    s_waitcnt vmcnt(4) lgkmcnt(10)
    v_mfma_f32_16x16x32_bf16 v[224:227], v[192:195], v[40:43], v[224:227]
    v_add_u32 v4, s72, v4
    ds_read_b64_tr_b16 v[128:129], v4 offset:0
    s_waitcnt lgkmcnt(5)
    v_mfma_f32_16x16x32_bf16 v[228:231], v[196:199], v[40:43], v[228:231]
    ds_read_b64_tr_b16 v[130:131], v4 offset:512
    v_lshlrev_b32 v144, 16, v96
    v_mfma_f32_16x16x32_bf16 v[232:235], v[200:203], v[40:43], v[232:235]
    v_add_u32 v5, s72, v5
    ds_read_b64_tr_b16 v[132:133], v5 offset:0
    v_mfma_f32_16x16x32_bf16 v[236:239], v[204:207], v[40:43], v[236:239]
    ds_read_b64_tr_b16 v[134:135], v5 offset:512
    v_and_b32 v145, 0xffff0000, v96
    v_mfma_f32_16x16x32_bf16 v[252:255], v[204:207], v[44:47], v[252:255]
    v_add_u32 v6, s72, v6
    ds_read_b64_tr_b16 v[136:137], v6 offset:0
    v_mfma_f32_16x16x32_bf16 v[248:251], v[200:203], v[44:47], v[248:251]
    ds_read_b64_tr_b16 v[138:139], v6 offset:512
    v_lshlrev_b32 v146, 16, v97
    v_mfma_f32_16x16x32_bf16 v[244:247], v[196:199], v[44:47], v[244:247]
    v_add_u32 v7, s72, v7
    ds_read_b64_tr_b16 v[140:141], v7 offset:0
    v_mfma_f32_16x16x32_bf16 v[240:243], v[192:195], v[44:47], v[240:243]
    ds_read_b64_tr_b16 v[142:143], v7 offset:512
    s_waitcnt vmcnt(2) lgkmcnt(8)
    v_mfma_f32_16x16x32_bf16 v[240:243], v[112:115], v[52:55], v[240:243]
    v_and_b32 v147, 0xffff0000, v97
    v_lshlrev_b32 v148, 16, v98
    v_mfma_f32_16x16x32_bf16 v[244:247], v[116:119], v[52:55], v[244:247]
    v_and_b32 v149, 0xffff0000, v98
    v_lshlrev_b32 v150, 16, v99
    v_mfma_f32_16x16x32_bf16 v[248:251], v[120:123], v[52:55], v[248:251]
    v_and_b32 v151, 0xffff0000, v99
    v_sub_f32 v152, v144, v88
    v_mfma_f32_16x16x32_bf16 v[252:255], v[124:127], v[52:55], v[252:255]
    v_sub_f32 v153, v145, v88
    v_sub_f32 v154, v146, v88
    v_mfma_f32_16x16x32_bf16 v[236:239], v[124:127], v[48:51], v[236:239]
    v_sub_f32 v155, v147, v88
    v_sub_f32 v156, v148, v88
    v_mfma_f32_16x16x32_bf16 v[232:235], v[120:123], v[48:51], v[232:235]
    v_sub_f32 v157, v149, v88
    v_sub_f32 v158, v150, v88
    v_mfma_f32_16x16x32_bf16 v[228:231], v[116:119], v[48:51], v[228:231]
    v_sub_f32 v159, v151, v88
    v_mul_f32 v152, v152, v90
    v_mfma_f32_16x16x32_bf16 v[224:227], v[112:115], v[48:51], v[224:227]
    v_mul_f32 v153, v153, v90
    v_mul_f32 v154, v154, v90
    s_waitcnt vmcnt(0) lgkmcnt(0)
    v_mfma_f32_16x16x32_bf16 v[224:227], v[128:131], v[56:59], v[224:227]
    v_mul_f32 v155, v155, v90
    v_mul_f32 v156, v156, v90
    v_mfma_f32_16x16x32_bf16 v[228:231], v[132:135], v[56:59], v[228:231]
    v_mul_f32 v157, v157, v90
    v_mul_f32 v158, v158, v90
    v_mfma_f32_16x16x32_bf16 v[232:235], v[136:139], v[56:59], v[232:235]
    v_mul_f32 v159, v159, v90
    v_mfma_f32_16x16x32_bf16 v[236:239], v[140:143], v[56:59], v[236:239]
    v_mfma_f32_16x16x32_bf16 v[248:251], v[136:139], v[60:63], v[248:251]
    v_mfma_f32_16x16x32_bf16 v[252:255], v[140:143], v[60:63], v[252:255]
    v_mfma_f32_16x16x32_bf16 v[240:243], v[128:131], v[60:63], v[240:243]
    v_mfma_f32_16x16x32_bf16 v[244:247], v[132:135], v[60:63], v[244:247]
    s_nop 0
    ds_write_b128 v80, v[224:227] offset:0
    ds_write_b128 v80, v[228:231] offset:1024
    ds_write_b128 v80, v[232:235] offset:2048
    ds_write_b128 v80, v[236:239] offset:3072
    ds_write_b128 v81, v[248:251] offset:4096
    ds_write_b128 v81, v[252:255] offset:5120
    s_waitcnt lgkmcnt(0)
    s_barrier
    ds_read_b128 v[160:163], v81 offset:0
    ds_read_b128 v[164:167], v81 offset:1024
L_final:
    ds_read_b64_tr_b16 v[96:97], v82 offset:0
    ds_read_b64_tr_b16 v[98:99], v82 offset:2048
    s_waitcnt lgkmcnt(2)
    v_pk_add_f32 v[160:161], v[160:161], v[240:241]
    v_pk_add_f32 v[162:163], v[162:163], v[242:243]
    v_pk_add_f32 v[164:165], v[164:165], v[244:245]
    v_pk_add_f32 v[166:167], v[166:167], v[246:247]
    v_pk_mul_f32 v[176:177], v[160:161], v[90:91] op_sel:[0,1] op_sel_hi:[1,1]
    v_pk_mul_f32 v[178:179], v[162:163], v[90:91] op_sel:[0,1] op_sel_hi:[1,1]
    v_pk_mul_f32 v[180:181], v[164:165], v[90:91] op_sel:[0,1] op_sel_hi:[1,1]
    v_pk_mul_f32 v[182:183], v[166:167], v[90:91] op_sel:[0,1] op_sel_hi:[1,1]
    v_exp_f32 v176, v176
    v_exp_f32 v177, v177
    v_exp_f32 v178, v178
    v_exp_f32 v179, v179
    v_exp_f32 v180, v180
    v_exp_f32 v181, v181
    v_exp_f32 v182, v182
    v_exp_f32 v183, v183
    v_pk_mul_f32 v[160:161], v[160:161], v[152:153]
    v_pk_mul_f32 v[162:163], v[162:163], v[154:155]
    v_pk_mul_f32 v[164:165], v[164:165], v[156:157]
    v_pk_mul_f32 v[166:167], v[166:167], v[158:159]
    v_pk_add_f32 v[176:177], v[176:177], 1.0 op_sel_hi:[1,0]
    v_pk_add_f32 v[178:179], v[178:179], 1.0 op_sel_hi:[1,0]
    v_pk_add_f32 v[180:181], v[180:181], 1.0 op_sel_hi:[1,0]
    v_pk_add_f32 v[182:183], v[182:183], 1.0 op_sel_hi:[1,0]
    v_rcp_f32 v176, v176
    v_rcp_f32 v177, v177
    v_rcp_f32 v178, v178
    v_rcp_f32 v179, v179
    v_rcp_f32 v180, v180
    v_rcp_f32 v181, v181
    v_rcp_f32 v182, v182
    v_rcp_f32 v183, v183
    s_waitcnt lgkmcnt(0)
    v_lshlrev_b32 v184, 16, v96
    v_and_b32 v185, 0xffff0000, v96
    v_lshlrev_b32 v186, 16, v97
    v_and_b32 v187, 0xffff0000, v97
    v_lshlrev_b32 v188, 16, v98
    v_and_b32 v189, 0xffff0000, v98
    v_lshlrev_b32 v190, 16, v99
    v_and_b32 v191, 0xffff0000, v99
    v_pk_mul_f32 v[160:161], v[160:161], v[176:177]
    v_pk_mul_f32 v[162:163], v[162:163], v[178:179]
    v_pk_mul_f32 v[164:165], v[164:165], v[180:181]
    v_pk_mul_f32 v[166:167], v[166:167], v[182:183]
    v_pk_fma_f32 v[160:161], v[160:161], v[184:185], v[144:145]
    v_pk_fma_f32 v[162:163], v[162:163], v[186:187], v[146:147]
    v_pk_fma_f32 v[164:165], v[164:165], v[188:189], v[148:149]
    v_pk_fma_f32 v[166:167], v[166:167], v[190:191], v[150:151]
    v_cvt_pk_bf16_f32 v104, v160, v161
    v_cvt_pk_bf16_f32 v105, v162, v163
    v_cvt_pk_bf16_f32 v106, v164, v165
    v_cvt_pk_bf16_f32 v107, v166, v167
    s_nop 1
    v_permlane16_swap_b32 v104, v106
    v_permlane16_swap_b32 v105, v107
    ds_write_b128 v86, v[104:107]
    ds_read_b128 v[104:107], v87
    s_waitcnt lgkmcnt(0)
    buffer_store_dwordx4 v[104:107], v83, s[36:39], 0 offen sc1
    s_endpgm
L_slow_c7:
    s_mov_b32 s60, 0
L_lw_51:
    ds_read_b32 v3, v15 offset:160
    s_add_u32 s60, s60, 1
    s_cmp_gt_u32 s60, 1600000
    s_cbranch_scc1 L_lwo_52
    s_waitcnt lgkmcnt(0)
    v_cmp_eq_u32 vcc, 0, v3
    s_cbranch_vccnz L_lw_51
L_lwo_52:
    s_waitcnt lgkmcnt(0)
    s_branch L_back_c7
L_slow_cs:
    s_mov_b32 s60, 0
L_lw_54:
    ds_read_b32 v3, v15 offset:176
    s_add_u32 s60, s60, 1
    s_cmp_gt_u32 s60, 1600000
    s_cbranch_scc1 L_lwo_55
    s_waitcnt lgkmcnt(0)
    v_cmp_eq_u32 vcc, 0, v3
    s_cbranch_vccnz L_lw_54
L_lwo_55:
    s_waitcnt lgkmcnt(0)
    s_branch L_back_cs
L_slow_xdma:
    s_mov_b32 s60, 0
L_lw_57:
    ds_read_b32 v3, v15 offset:32
    s_add_u32 s60, s60, 1
    s_cmp_gt_u32 s60, 1600000
    s_cbranch_scc1 L_lwo_58
    s_waitcnt lgkmcnt(0)
    v_cmp_eq_u32 vcc, 0, v3
    s_cbranch_vccnz L_lw_57
L_lwo_58:
    s_waitcnt lgkmcnt(0)
    s_branch L_back_xdma
L_xidle:
    s_setprio 0
    s_cmp_lg_u32 s53, 15
    s_cbranch_scc1 L_xpack1
    s_waitcnt vmcnt(0)
    buffer_store_dwordx4 v[112:115], v125, s[44:47], 0 offen offset:0 sc1
    buffer_store_dwordx4 v[116:119], v125, s[44:47], 0 offen offset:1024 sc1
    buffer_store_dwordx4 v[120:123], v125, s[44:47], 0 offen offset:2048 sc1
L_xpack1:
    s_barrier
    s_waitcnt lgkmcnt(0)
    s_barrier
    s_waitcnt vmcnt(0)
    s_barrier
    s_barrier
    s_barrier
    s_barrier
    s_mov_b32 s60, 0
    s_branch L_lwe_62
L_lw_60:
    s_sleep 1
L_lwe_62:
    ds_read_b32 v3, v15 offset:160
    s_add_u32 s60, s60, 1
    s_cmp_gt_u32 s60, 1600000
    s_cbranch_scc1 L_lwo_61
    s_waitcnt lgkmcnt(0)
    v_cmp_eq_u32 vcc, 0, v3
    s_cbranch_vccnz L_lw_60
L_lwo_61:
    s_waitcnt lgkmcnt(0)
    s_mov_b32 s60, 0
    s_branch L_lwe_65
L_lw_63:
    s_sleep 1
L_lwe_65:
    ds_read_b32 v3, v15 offset:176
    s_add_u32 s60, s60, 1
    s_cmp_gt_u32 s60, 1600000
    s_cbranch_scc1 L_lwo_64
    s_waitcnt lgkmcnt(0)
    v_cmp_eq_u32 vcc, 0, v3
    s_cbranch_vccnz L_lw_63
L_lwo_64:
    s_waitcnt lgkmcnt(0)
    ds_write_b32 v14, v13 offset:224
    ds_write_b32 v14, v13 offset:128
    s_waitcnt vmcnt(0)
    ds_write_b32 v14, v13 offset:0
    s_setprio 3
    s_branch L_xg2
L_slow_fin:
    s_mov_b32 s60, 0
L_lw_66:
    ds_read_b32 v3, v15 offset:144
    s_add_u32 s60, s60, 1
    s_cmp_gt_u32 s60, 1600000
    s_cbranch_scc1 L_lwo_67
    s_waitcnt lgkmcnt(0)
    v_cmp_eq_u32 vcc, 0, v3
    s_cbranch_vccnz L_lw_66
L_lwo_67:
    s_waitcnt lgkmcnt(0)
    s_mov_b32 s60, 0
L_lw_69:
    ds_read_b32 v3, v15 offset:192
    s_add_u32 s60, s60, 1
    s_cmp_gt_u32 s60, 1600000
    s_cbranch_scc1 L_lwo_70
    s_waitcnt lgkmcnt(0)
    v_cmp_eq_u32 vcc, 0, v3
    s_cbranch_vccnz L_lw_69
L_lwo_70:
    s_waitcnt lgkmcnt(0)
    s_branch L_back_fin
L_end:
    s_endpgm
.section .rodata,"a"
.p2align 6
.amdhsa_kernel recurrent_scan__ssm_conv_h3__glu_gated_bilinear__prompt_kernel
  .amdhsa_next_free_vgpr 256
  .amdhsa_next_free_sgpr 102
  .amdhsa_accum_offset 256
  .amdhsa_group_segment_fixed_size 0
  .amdhsa_kernarg_size 104
  .amdhsa_user_sgpr_count 2
  .amdhsa_user_sgpr_kernarg_segment_ptr 1
  .amdhsa_system_sgpr_workgroup_id_x 1
.end_amdhsa_kernel
```
